```python
import torch

def _softmax(x, axis=-1):
    return torch.softmax(x, dim=axis)
def _gelu(x):
    return torch.nn.functional.gelu(x, approximate="tanh")
def _silu(x):
    return torch.nn.functional.silu(x)
def _sigmoid(x):
    return torch.sigmoid(x)
def _layernorm(x, axis=-1, eps=1e-5):
    m = x.mean(dim=axis, keepdim=True)
    v = x.var(dim=axis, keepdim=True, unbiased=False)
    return (x - m) / torch.sqrt(v + eps)
def _scatter_add(tgt, idx, src, axis=0):
    return tgt.clone().index_add_(axis, idx, src)
def _segment_sum(src, seg, n):
    out = torch.zeros((n,) + src.shape[1:], dtype=src.dtype)
    return out.index_add_(0, seg, src)
def _pad(x, pw):
    flat = tuple(v for pair in reversed(pw) for v in pair)
    return torch.nn.functional.pad(x, flat)

kernel_name = 'gated_mix__ssm_conv_h3__mixer_channel_mlp__prompt'

def setup_inputs():

    _w = (lambda a: (lambda t: t.to(torch.bfloat16) if t.is_floating_point() else t)(torch.as_tensor(a)))
    def _A_setup():
        B, S, D = 1, 2048, 640
        ks = 4
        return {
            "q": _w((lambda *s: torch.randn(*s, dtype=torch.bfloat16) * 0.05)(B, S, D)),
            "k": _w((lambda *s: torch.randn(*s, dtype=torch.bfloat16) * 0.4)(B, S, D)),
            "v": _w((lambda *s: torch.randn(*s, dtype=torch.bfloat16) * 0.4)(B, S, D)),
            "shift_k": _w((lambda *s: torch.randn(*s, dtype=torch.bfloat16) * 0.4)(D, ks) * 0.5),
            "ssm_k": _w((lambda *s: torch.randn(*s, dtype=torch.bfloat16) * 1.6)(D, S) * (1.0 / S ** 0.5)),
            "ssm_D": _w((lambda *s: torch.randn(*s, dtype=torch.bfloat16) * 0.4)(D)),
        }
    _A_in = _A_setup()

    def _B_setup():
        B, S, D, F = 1, 2048, 640, 1536
        return {
            "x": _w((lambda *s: torch.randn(*s, dtype=torch.bfloat16) * 0.05)(B, S, D)),
            "w1": _w((lambda *s: torch.randn(*s, dtype=torch.bfloat16) * 0.8)(D, F) * (D ** -0.5)),
            "b1": _w((lambda *s: torch.randn(*s, dtype=torch.bfloat16) * 0.4)(F)),
            "w2": _w((lambda *s: torch.randn(*s, dtype=torch.bfloat16) * 0.05)(F, D) * (F ** -0.5)),
            "b2": _w((lambda *s: torch.randn(*s, dtype=torch.bfloat16) * 0.05)(D)),
        }
    _B_in = _B_setup()

    return {
        "A_q": _A_in["q"],
        "A_k": _A_in["k"],
        "A_v": _A_in["v"],
        "A_shift_k": _A_in["shift_k"],
        "A_ssm_k": _A_in["ssm_k"],
        "A_ssm_D": _A_in["ssm_D"],
        "B_x": _B_in["x"],
        "B_w1": _B_in["w1"],
        "B_b1": _B_in["b1"],
        "B_w2": _B_in["w2"],
        "B_b2": _B_in["b2"],
        "gate_w": _w((lambda *s: torch.randn(*s, dtype=torch.bfloat16) * 0.05)(640) * 16.0),
    }

def reference(A_q, A_k, A_v, A_shift_k, A_ssm_k, A_ssm_D, B_x, B_w1, B_b1, B_w2, B_b2, gate_w):
    def _A_ref(q, k, v, shift_k, ssm_k, ssm_D):
        B, S, D = q.shape
        ks = shift_k.shape[-1]
        k_pad = _pad(k, ((0, 0), (ks - 1, 0), (0, 0)))
        k_shift = torch.zeros_like(k)
        for t in range(ks):
            k_shift = k_shift + k_pad[:, t:t + S, :] * shift_k[:, ks - 1 - t][None, None, :]
        kv = k_shift * v
        L = 2 * S
        kv_pad = _pad(kv, ((0, 0), (0, S), (0, 0)))
        kf_pad = _pad(ssm_k, ((0, 0), (0, S)))
        kv_f = (lambda x, axes=(-2,-1): torch.fft.rfft2(x.float(), dim=axes))(kv_pad[:, None, :, :], axes=(1, 2))
        kf_f = (lambda x, axes=(-2,-1): torch.fft.rfft2(x.float(), dim=axes))(kf_pad[:, None, :], axes=(1, 2))
        kf_f = (lambda x, *d: x.permute(*d))(kf_f, 1, 2, 0)
        y_f = kv_f * kf_f[None, :, :, :]
        y = (lambda x, s, axes=(-2,-1): torch.fft.irfft2(x, s=s, dim=axes).to(torch.bfloat16))(y_f, (1, L), axes=(1, 2))[:, 0, :S, :]
        y = y + kv * ssm_D[None, None, :]
        return q * y

    def _B_ref(x, w1, b1, w2, b2):
        y = _layernorm(x, axis=-1)
        h = _gelu(torch.einsum("bsd,df->bsf", y, w1) + b1)
        return torch.einsum("bsf,fd->bsd", h, w2) + b2

    x = A_q
    g = _sigmoid((x * gate_w).sum(-1, keepdims=True))
    a = _A_ref(x, A_k, A_v, A_shift_k, A_ssm_k, A_ssm_D)
    b = _B_ref(x, B_w1, B_b1, B_w2, B_b2)
    return g * a + (1 - g) * b
```

```asm
; @launch grid=(256,1,1) block=(512,1,1) lds=163840
.amdgcn_target "amdgcn-amd-amdhsa--gfx950"
.text
.globl gated_mix__ssm_conv_h3__mixer_channel_mlp__prompt_kernel
.p2align 8
.type gated_mix__ssm_conv_h3__mixer_channel_mlp__prompt_kernel,@function
gated_mix__ssm_conv_h3__mixer_channel_mlp__prompt_kernel:
s_load_dwordx16 s[32:47], s[0:1], 0
s_load_dwordx16 s[48:63], s[0:1], 56
s_cmp_ge_u32 s2, 256
s_cbranch_scc1 K_end
s_lshr_b32 s65, s2, 3
v_lshrrev_b32 v1, 6, v0
s_and_b32 s64, s2, 7
v_readfirstlane_b32 s3, v1
v_and_b32 v0, 63, v0
s_lshr_b32 s72, s64, 1
s_and_b32 s73, s64, 1
s_lshr_b32 s74, s65, 2
s_lshl3_add_u32 s70, s72, s74
s_and_b32 s75, s65, 3
s_lshl2_add_u32 s71, s73, s75
s_mul_i32 s74, s74, 3
s_mul_i32 s75, s75, 6
s_add_u32 s74, s74, s75
s_lshr_b32 s74, s74, 1
s_cmp_ge_u32 s74, 12
s_cselect_b32 s75, 12, 0
s_sub_u32 s92, s74, s75
s_cmp_lt_u32 s65, 8
s_cbranch_scc1 KP
s_sub_u32 s67, s65, 8
s_mul_i32 s66, s67, 43
s_lshr_b32 s66, s66, 8
s_mul_i32 s74, s66, 6
s_sub_u32 s67, s67, s74
s_lshl2_add_u32 s68, s72, s66
s_mul_i32 s69, s73, 6
s_add_u32 s69, s69, s67
s_cmp_lt_u32 s3, 4
s_cbranch_scc1 MG0
s_sub_u32 s3, s3, 4
s_mul_i32 s80, s66, 5
s_add_u32 s80, s80, 1
s_lshr_b32 s80, s80, 1
s_lshl1_add_u32 s80, s67, s80
s_cmp_ge_u32 s80, 10
s_cselect_b32 s81, 10, 0
s_sub_u32 s80, s80, s81
v_lshrrev_b32 v1, 3, v0
v_lshrrev_b32 v2, 4, v0
v_and_b32 v3, 7, v0
v_xor_b32 v3, v3, v2
v_mul_u32_u24 v1, 1280, v1
v_lshl_add_u32 v4, v3, 4, v1
v_xor_b32 v5, 64, v4
v_add_u32 v6, 18432, v4
v_add_u32 v7, 27648, v5
v_add_u32 v5, 9216, v5
v_and_b32 v3, 15, v0
v_lshlrev_b32 v1, 2, v2
v_xor_b32 v1, v1, v3
v_mul_u32_u24 v8, 3072, v2
v_lshl_add_u32 v8, v1, 4, v8
v_add_u32 v9, 11264, v8
v_add_u32 v10, 22528, v8
v_add_u32 v11, 33792, v8
v_lshlrev_b32 v1, 4, v0
s_lshl_b32 s72, s3, 12
s_add_u32 s73, s72, 16384
s_lshl2_add_u32 s74, s68, s3
s_mul_i32 s74, s74, 40960
s_mul_i32 s75, s3, 49152
s_lshl_b32 s76, s69, 8
s_add_u32 s75, s75, s76
s_lshl_b32 s78, s80, 7
s_mul_i32 s79, s80, 196608
s_mov_b32 s6, 2621440
s_mov_b32 s7, 0x20000
s_mov_b32 s10, 1966080
s_mov_b32 s11, 0x20000
s_waitcnt lgkmcnt(0)
s_mov_b32 s4, s32
s_mov_b32 s5, s33
s_mov_b32 s8, s48
s_mov_b32 s9, s49
s_add_u32 m0, s72, 0
s_add_u32 s76, s74, s78
buffer_load_dwordx4 v4, s[4:7], s76 offen offset:0 lds
buffer_load_dwordx4 v5, s[4:7], s76 offen offset:1024 lds
buffer_load_dwordx4 v6, s[4:7], s76 offen offset:2048 lds
buffer_load_dwordx4 v7, s[4:7], s76 offen offset:3072 lds
s_add_u32 m0, s73, 0
s_add_u32 s77, s75, s79
buffer_load_dwordx4 v8, s[8:11], s77 offen offset:0 lds
buffer_load_dwordx4 v9, s[8:11], s77 offen offset:1024 lds
buffer_load_dwordx4 v10, s[8:11], s77 offen offset:2048 lds
buffer_load_dwordx4 v11, s[8:11], s77 offen offset:3072 lds
s_add_u32 s78, s78, 128
s_add_u32 s79, s79, 196608
s_cmp_eq_u32 s78, 1280
s_cselect_b32 s78, 0, s78
s_cselect_b32 s79, 0, s79
s_load_dword s96, s[62:63], 0
s_mul_i32 s80, s64, 24
s_add_u32 s80, s80, s65
s_sub_u32 s80, s80, 8
s_lshr_b32 s86, s3, 1
s_lshl1_add_u32 s83, s80, s86
s_and_b32 s82, s3, 1
s_mul_i32 s86, s86, 21216
s_add_u32 s86, s86, 103872
s_add_u32 m0, s72, 32768
s_add_u32 s76, s74, s78
buffer_load_dwordx4 v4, s[4:7], s76 offen offset:0 lds
buffer_load_dwordx4 v5, s[4:7], s76 offen offset:1024 lds
buffer_load_dwordx4 v6, s[4:7], s76 offen offset:2048 lds
buffer_load_dwordx4 v7, s[4:7], s76 offen offset:3072 lds
s_add_u32 m0, s73, 32768
s_add_u32 s77, s75, s79
buffer_load_dwordx4 v8, s[8:11], s77 offen offset:0 lds
buffer_load_dwordx4 v9, s[8:11], s77 offen offset:1024 lds
buffer_load_dwordx4 v10, s[8:11], s77 offen offset:2048 lds
buffer_load_dwordx4 v11, s[8:11], s77 offen offset:3072 lds
s_add_u32 s78, s78, 128
s_add_u32 s79, s79, 196608
s_cmp_eq_u32 s78, 1280
s_cselect_b32 s78, 0, s78
s_cselect_b32 s79, 0, s79
s_mov_b32 s12, s62
s_mov_b32 s13, s63
s_mov_b32 s14, 268435456
s_mov_b32 s15, 0x20000
s_mul_i32 s94, s64, 10
s_lshr_b32 s87, s83, 6
s_add_u32 s94, s94, s87
s_mul_i32 s94, s94, 4352
s_add_u32 s94, s94, 14110720
v_and_b32 v225, 31, v0
v_lshlrev_b32 v225, 2, v225
s_lshr_b32 s93, s64, 1
s_lshl3_add_u32 s93, s93, s71
s_lshl2_add_u32 s93, s93, s3
s_mul_i32 s93, s93, 4352
s_add_u32 s93, s93, 14458880
v_min_u32 v227, 23, v0
v_lshlrev_b32 v227, 2, v227
s_mul_i32 s99, s71, 245760
s_mul_i32 s85, s3, 12
s_add_u32 s85, s85, s92
s_mul_i32 s85, s85, 5120
s_add_u32 s99, s99, s85
s_add_u32 s99, s99, 5246976
s_sub_u32 s60, s99, 61440
s_mul_i32 s100, s3, 5120
s_mul_i32 s101, s82, 10240
s_add_u32 s101, s101, s86
s_sub_u32 s101, s101, 42432
s_waitcnt lgkmcnt(0)
s_add_u32 s96, s96, 0x9e3779b9
s_lshl1_add_u32 s95, s68, s82
s_lshl_b32 s95, s95, 10
s_add_u32 s95, s95, 13504512
s_lshl_b32 s98, s82, 10
s_add_u32 s98, s98, 146304
s_waitcnt vmcnt(8)
s_barrier
s_add_u32 m0, s72, 65536
s_add_u32 s76, s74, s78
buffer_load_dwordx4 v4, s[4:7], s76 offen offset:0 lds
buffer_load_dwordx4 v5, s[4:7], s76 offen offset:1024 lds
buffer_load_dwordx4 v6, s[4:7], s76 offen offset:2048 lds
buffer_load_dwordx4 v7, s[4:7], s76 offen offset:3072 lds
s_add_u32 m0, s73, 65536
s_add_u32 s77, s75, s79
buffer_load_dwordx4 v8, s[8:11], s77 offen offset:0 lds
buffer_load_dwordx4 v9, s[8:11], s77 offen offset:1024 lds
buffer_load_dwordx4 v10, s[8:11], s77 offen offset:2048 lds
buffer_load_dwordx4 v11, s[8:11], s77 offen offset:3072 lds
s_add_u32 s78, s78, 128
s_add_u32 s79, s79, 196608
s_cmp_eq_u32 s78, 1280
s_cselect_b32 s78, 0, s78
s_cselect_b32 s79, 0, s79
s_waitcnt vmcnt(8)
s_barrier
s_add_u32 m0, s72, 0
s_add_u32 s76, s74, s78
buffer_load_dwordx4 v4, s[4:7], s76 offen offset:0 lds
buffer_load_dwordx4 v5, s[4:7], s76 offen offset:1024 lds
buffer_load_dwordx4 v6, s[4:7], s76 offen offset:2048 lds
buffer_load_dwordx4 v7, s[4:7], s76 offen offset:3072 lds
s_add_u32 m0, s73, 0
s_add_u32 s77, s75, s79
buffer_load_dwordx4 v8, s[8:11], s77 offen offset:0 lds
buffer_load_dwordx4 v9, s[8:11], s77 offen offset:1024 lds
buffer_load_dwordx4 v10, s[8:11], s77 offen offset:2048 lds
buffer_load_dwordx4 v11, s[8:11], s77 offen offset:3072 lds
s_add_u32 s78, s78, 128
s_add_u32 s79, s79, 196608
s_cmp_eq_u32 s78, 1280
s_cselect_b32 s78, 0, s78
s_cselect_b32 s79, 0, s79
s_waitcnt vmcnt(8)
s_barrier
s_add_u32 m0, s72, 32768
s_add_u32 s76, s74, s78
buffer_load_dwordx4 v4, s[4:7], s76 offen offset:0 lds
buffer_load_dwordx4 v5, s[4:7], s76 offen offset:1024 lds
buffer_load_dwordx4 v6, s[4:7], s76 offen offset:2048 lds
buffer_load_dwordx4 v7, s[4:7], s76 offen offset:3072 lds
s_add_u32 m0, s73, 32768
s_add_u32 s77, s75, s79
buffer_load_dwordx4 v8, s[8:11], s77 offen offset:0 lds
buffer_load_dwordx4 v9, s[8:11], s77 offen offset:1024 lds
buffer_load_dwordx4 v10, s[8:11], s77 offen offset:2048 lds
buffer_load_dwordx4 v11, s[8:11], s77 offen offset:3072 lds
s_add_u32 s78, s78, 128
s_add_u32 s79, s79, 196608
s_cmp_eq_u32 s78, 1280
s_cselect_b32 s78, 0, s78
s_cselect_b32 s79, 0, s79
s_waitcnt vmcnt(8)
s_barrier
s_add_u32 m0, s72, 65536
s_add_u32 s76, s74, s78
buffer_load_dwordx4 v4, s[4:7], s76 offen offset:0 lds
buffer_load_dwordx4 v5, s[4:7], s76 offen offset:1024 lds
buffer_load_dwordx4 v6, s[4:7], s76 offen offset:2048 lds
buffer_load_dwordx4 v7, s[4:7], s76 offen offset:3072 lds
s_add_u32 m0, s73, 65536
s_add_u32 s77, s75, s79
buffer_load_dwordx4 v8, s[8:11], s77 offen offset:0 lds
buffer_load_dwordx4 v9, s[8:11], s77 offen offset:1024 lds
buffer_load_dwordx4 v10, s[8:11], s77 offen offset:2048 lds
buffer_load_dwordx4 v11, s[8:11], s77 offen offset:3072 lds
s_add_u32 s78, s78, 128
s_add_u32 s79, s79, 196608
s_cmp_eq_u32 s78, 1280
s_cselect_b32 s78, 0, s78
s_cselect_b32 s79, 0, s79
s_waitcnt vmcnt(8)
s_barrier
s_add_u32 m0, s72, 0
s_add_u32 s76, s74, s78
buffer_load_dwordx4 v4, s[4:7], s76 offen offset:0 lds
buffer_load_dwordx4 v5, s[4:7], s76 offen offset:1024 lds
buffer_load_dwordx4 v6, s[4:7], s76 offen offset:2048 lds
buffer_load_dwordx4 v7, s[4:7], s76 offen offset:3072 lds
s_add_u32 m0, s73, 0
s_add_u32 s77, s75, s79
buffer_load_dwordx4 v8, s[8:11], s77 offen offset:0 lds
buffer_load_dwordx4 v9, s[8:11], s77 offen offset:1024 lds
buffer_load_dwordx4 v10, s[8:11], s77 offen offset:2048 lds
buffer_load_dwordx4 v11, s[8:11], s77 offen offset:3072 lds
s_add_u32 s78, s78, 128
s_add_u32 s79, s79, 196608
s_cmp_eq_u32 s78, 1280
s_cselect_b32 s78, 0, s78
s_cselect_b32 s79, 0, s79
s_waitcnt vmcnt(8)
s_barrier
s_add_u32 m0, s72, 32768
s_add_u32 s76, s74, s78
buffer_load_dwordx4 v4, s[4:7], s76 offen offset:0 lds
buffer_load_dwordx4 v5, s[4:7], s76 offen offset:1024 lds
buffer_load_dwordx4 v6, s[4:7], s76 offen offset:2048 lds
buffer_load_dwordx4 v7, s[4:7], s76 offen offset:3072 lds
s_add_u32 m0, s73, 32768
s_add_u32 s77, s75, s79
buffer_load_dwordx4 v8, s[8:11], s77 offen offset:0 lds
buffer_load_dwordx4 v9, s[8:11], s77 offen offset:1024 lds
buffer_load_dwordx4 v10, s[8:11], s77 offen offset:2048 lds
buffer_load_dwordx4 v11, s[8:11], s77 offen offset:3072 lds
s_add_u32 s78, s78, 128
s_add_u32 s79, s79, 196608
s_cmp_eq_u32 s78, 1280
s_cselect_b32 s78, 0, s78
s_cselect_b32 s79, 0, s79
s_waitcnt vmcnt(8)
s_barrier
s_add_u32 m0, s72, 65536
s_add_u32 s76, s74, s78
buffer_load_dwordx4 v4, s[4:7], s76 offen offset:0 lds
buffer_load_dwordx4 v5, s[4:7], s76 offen offset:1024 lds
buffer_load_dwordx4 v6, s[4:7], s76 offen offset:2048 lds
buffer_load_dwordx4 v7, s[4:7], s76 offen offset:3072 lds
s_add_u32 m0, s73, 65536
s_add_u32 s77, s75, s79
buffer_load_dwordx4 v8, s[8:11], s77 offen offset:0 lds
buffer_load_dwordx4 v9, s[8:11], s77 offen offset:1024 lds
buffer_load_dwordx4 v10, s[8:11], s77 offen offset:2048 lds
buffer_load_dwordx4 v11, s[8:11], s77 offen offset:3072 lds
s_add_u32 s78, s78, 128
s_add_u32 s79, s79, 196608
s_cmp_eq_u32 s78, 1280
s_cselect_b32 s78, 0, s78
s_cselect_b32 s79, 0, s79
buffer_load_dword v226, v227, s[12:15], s93 offen sc1
s_waitcnt vmcnt(9)
s_barrier
s_add_u32 m0, s72, 0
s_add_u32 s76, s74, s78
buffer_load_dwordx4 v4, s[4:7], s76 offen offset:0 lds
buffer_load_dwordx4 v5, s[4:7], s76 offen offset:1024 lds
buffer_load_dwordx4 v6, s[4:7], s76 offen offset:2048 lds
buffer_load_dwordx4 v7, s[4:7], s76 offen offset:3072 lds
s_add_u32 m0, s73, 0
s_add_u32 s77, s75, s79
buffer_load_dwordx4 v8, s[8:11], s77 offen offset:0 lds
buffer_load_dwordx4 v9, s[8:11], s77 offen offset:1024 lds
buffer_load_dwordx4 v10, s[8:11], s77 offen offset:2048 lds
buffer_load_dwordx4 v11, s[8:11], s77 offen offset:3072 lds
s_lshl_b32 s84, s83, 12
s_add_u32 s20, s40, s84
s_addc_u32 s21, s41, 0
s_movk_i32 s22, 4096
s_mov_b32 s23, 0x20000
s_mov_b32 s24, s42
s_mov_b32 s25, s43
s_movk_i32 s26, 1280
s_mov_b32 s27, 0x20000
s_lshl_b32 s84, s82, 11
v_lshlrev_b32 v108, 4, v0
v_add_u32 v108, s84, v108
s_lshl_b32 s85, s83, 1
v_mov_b32 v109, 0
buffer_load_dwordx4 v[58:61], v108, s[20:23], 0 offen offset:0
buffer_load_dwordx2 v[62:63], v108, s[20:23], 0 offen offset:16
buffer_load_dwordx4 v[64:67], v108, s[20:23], 0 offen offset:1024
buffer_load_dwordx2 v[68:69], v108, s[20:23], 0 offen offset:1040
buffer_load_ushort v70, v109, s[24:27], s85 offen
s_waitcnt vmcnt(14)
s_barrier
s_mov_b32 m0, s98
s_nop 0
buffer_load_dwordx4 v1, s[12:15], s95 offen sc1 lds
s_mov_b32 s97, 0
s_waitcnt vmcnt(14)
v_cmp_ne_u32 vcc, s96, v226
s_nop 1
s_cbranch_vccz MG1_wp_done
MG1_wp_loop:
buffer_load_dword v226, v227, s[12:15], s93 offen sc1
s_add_u32 s97, s97, 1
s_waitcnt vmcnt(0)
v_cmp_ne_u32 vcc, s96, v226
s_cmp_ge_u32 s97, 32768
s_cbranch_scc1 MG1_wp_done
s_cbranch_vccnz MG1_wp_loop
MG1_wp_done:
s_add_u32 m0, s100, 40960
s_cmp_ge_u32 s92, 5
s_cselect_b32 s76, s60, s99
s_add_u32 s76, s76, 35840
buffer_load_dwordx4 v1, s[12:15], s76 offen offset:0 lds
buffer_load_dwordx4 v1, s[12:15], s76 offen offset:1024 lds
buffer_load_dwordx4 v1, s[12:15], s76 offen offset:2048 lds
buffer_load_dwordx4 v1, s[12:15], s76 offen offset:3072 lds
s_add_u32 m0, s100, 45056
s_add_u32 s76, s76, 4096
buffer_load_dwordx4 v1, s[12:15], s76 offen offset:0 lds
s_waitcnt vmcnt(11)
s_barrier
s_add_u32 m0, s101, 0
s_cmp_ge_u32 s92, 4
s_cselect_b32 s76, s60, s99
s_add_u32 s76, s76, 40960
buffer_load_dwordx4 v1, s[12:15], s76 offen offset:0 lds
buffer_load_dwordx4 v1, s[12:15], s76 offen offset:1024 lds
buffer_load_dwordx4 v1, s[12:15], s76 offen offset:2048 lds
buffer_load_dwordx4 v1, s[12:15], s76 offen offset:3072 lds
s_add_u32 m0, s101, 4096
s_add_u32 s76, s76, 4096
buffer_load_dwordx4 v1, s[12:15], s76 offen offset:0 lds
v_and_b32 v9, 15, v0
v_add_u32 v10, 1, v9
v_and_b32 v11, 3, v10
v_mul_u32_u24 v12, 4160, v11
s_lshl_b32 s87, s82, 8
s_add_u32 s87, s87, s86
v_and_b32 v10, 28, v10
v_lshl_add_u32 v12, v10, 1, v12
v_and_b32 v11, 48, v0
v_add3_u32 v12, v12, v11, s87
v_add_u32 v13, 2048, v12
v_lshlrev_b32 v9, 5, v9
v_sub_u32 v14, v11, v9
s_add_u32 s87, s87, 17120
v_add_u32 v14, s87, v14
s_lshl_b32 s84, s3, 2
s_add_u32 s84, s84, 163728
v_mov_b32 v15, s84
s_waitcnt vmcnt(10)
s_barrier
buffer_load_dword v224, v225, s[12:15], s94 offen sc1
v_mov_b32 v72, 0
v_mov_b32 v73, 0
v_mov_b32 v74, 0
v_mov_b32 v75, 0
v_bfe_u32 v76, v0, 1, 2
v_mul_u32_u24 v76, 4160, v76
v_and_b32 v77, 1, v0
v_lshl_add_u32 v76, v77, 4, v76
v_min_u32 v77, 29, v0
v_lshlrev_b32 v77, 4, v77
v_add_u32 v77, 20736, v77
s_cmp_eq_u32 s82, 0
s_cselect_b64 vcc, -1, 0
s_cselect_b64 s[88:89], 1, 0
v_cndmask_b32 v76, v77, v76, vcc
v_add_u32 v76, s86, v76
ds_write_b128 v76, v[72:75]
s_lshl_b32 s84, s82, 11
s_add_u32 s84, s84, s86
v_lshlrev_b32 v76, 4, v0
v_add_u32 v76, s84, v76
v_lshlrev_b32 v77, 16, v70
v_lshlrev_b32 v78, 16, v58
v_add_f32 v77, v77, v78
v_and_b32 v78, 0xffff0000, v58
v_cvt_pk_bf16_f32 v77, v77, v78
s_nop 0
v_cndmask_b32 v58, v58, v77, s[88:89]
ds_write_b128 v76, v[58:61] offset:32
v_alignbit_b32 v80, v59, v58, 16
v_alignbit_b32 v81, v60, v59, 16
v_alignbit_b32 v82, v61, v60, 16
v_alignbit_b32 v83, v62, v61, 16
ds_write_b128 v76, v[80:83] offset:4192
v_mov_b32 v84, v59
v_mov_b32 v85, v60
v_mov_b32 v86, v61
v_mov_b32 v87, v62
ds_write_b128 v76, v[84:87] offset:8352
v_alignbit_b32 v88, v60, v59, 16
v_alignbit_b32 v89, v61, v60, 16
v_alignbit_b32 v90, v62, v61, 16
v_alignbit_b32 v91, v63, v62, 16
ds_write_b128 v76, v[88:91] offset:12512
v_lshlrev_b32 v78, 16, v58
v_mov_b32 v79, v80
s_mov_b64 exec, s[88:89]
ds_write_b32 v76, v78 offset:4188
ds_write_b32 v76, v58 offset:8348
ds_write_b64 v76, v[78:79] offset:12504
s_mov_b64 exec, -1
ds_write_b128 v76, v[64:67] offset:1056
v_alignbit_b32 v92, v65, v64, 16
v_alignbit_b32 v93, v66, v65, 16
v_alignbit_b32 v94, v67, v66, 16
v_alignbit_b32 v95, v68, v67, 16
ds_write_b128 v76, v[92:95] offset:5216
v_mov_b32 v96, v65
v_mov_b32 v97, v66
v_mov_b32 v98, v67
v_mov_b32 v99, v68
ds_write_b128 v76, v[96:99] offset:9376
v_alignbit_b32 v100, v66, v65, 16
v_alignbit_b32 v101, v67, v66, 16
v_alignbit_b32 v102, v68, v67, 16
v_alignbit_b32 v103, v69, v68, 16
ds_write_b128 v76, v[100:103] offset:13536
s_waitcnt vmcnt(0)
v_cmp_ne_u32 vcc, s96, v224
s_mov_b32 s97, 0
s_waitcnt lgkmcnt(0)
s_cbranch_vccnz MG1_ulate
s_add_u32 m0, s86, 16640
s_lshl_b32 s87, s83, 12
s_add_u32 s87, s87, 4096
buffer_load_dwordx4 v1, s[12:15], s87 offen offset:0 lds
buffer_load_dwordx4 v1, s[12:15], s87 offen offset:1024 lds
buffer_load_dwordx4 v1, s[12:15], s87 offen offset:2048 lds
buffer_load_dwordx4 v1, s[12:15], s87 offen offset:3072 lds
s_waitcnt vmcnt(0)
s_barrier
s_branch MG1_uok
MG1_ulate:
s_barrier
s_mov_b32 s97, 0
MG1_up_loop:
buffer_load_dword v224, v225, s[12:15], s94 offen sc1
s_add_u32 s97, s97, 1
s_waitcnt vmcnt(0)
v_cmp_ne_u32 vcc, s96, v224
s_cmp_ge_u32 s97, 32768
s_cbranch_scc1 MG1_up_done
s_cbranch_vccnz MG1_up_loop
MG1_up_done:
s_add_u32 m0, s86, 16640
s_lshl_b32 s87, s83, 12
s_add_u32 s87, s87, 4096
buffer_load_dwordx4 v1, s[12:15], s87 offen offset:0 lds
buffer_load_dwordx4 v1, s[12:15], s87 offen offset:1024 lds
buffer_load_dwordx4 v1, s[12:15], s87 offen offset:2048 lds
buffer_load_dwordx4 v1, s[12:15], s87 offen offset:3072 lds
s_waitcnt vmcnt(0)
MG1_uok:
ds_read2_b64 v[128:131], v12 offset0:0 offset1:1
ds_read_b128 v[160:163], v14 offset:3584
ds_read2_b64 v[132:135], v12 offset0:64 offset1:65
ds_read_b128 v[164:167], v14 offset:3072
ds_read2_b64 v[136:139], v12 offset0:128 offset1:129
ds_read_b128 v[168:171], v14 offset:2560
ds_read2_b64 v[140:143], v12 offset0:192 offset1:193
ds_read_b128 v[172:175], v14 offset:2048
ds_read2_b64 v[144:147], v13 offset0:0 offset1:1
ds_read_b128 v[176:179], v14 offset:1536
ds_read2_b64 v[148:151], v13 offset0:64 offset1:65
ds_read_b128 v[180:183], v14 offset:1024
ds_read2_b64 v[152:155], v13 offset0:128 offset1:129
ds_read_b128 v[184:187], v14 offset:512
ds_read2_b64 v[156:159], v13 offset0:192 offset1:193
ds_read_b128 v[188:191], v14 offset:0
s_add_u32 m0, s100, 0
s_cmp_ge_u32 s92, 7
s_cselect_b32 s76, s60, s99
s_add_u32 s76, s76, 25600
buffer_load_dwordx4 v1, s[12:15], s76 offen offset:0 lds
buffer_load_dwordx4 v1, s[12:15], s76 offen offset:1024 lds
buffer_load_dwordx4 v1, s[12:15], s76 offen offset:2048 lds
buffer_load_dwordx4 v1, s[12:15], s76 offen offset:3072 lds
s_add_u32 m0, s100, 4096
s_add_u32 s76, s76, 4096
buffer_load_dwordx4 v1, s[12:15], s76 offen offset:0 lds
s_setprio 1
s_waitcnt lgkmcnt(0)
v_mfma_f32_16x16x32_bf16 v[220:223], v[140:143], v[176:179], 0
ds_read2_b64 v[64:67], v12 offset0:8 offset1:9
v_mfma_f32_16x16x32_bf16 v[216:219], v[140:143], v[172:175], 0
ds_read_b128 v[96:99], v14 offset:3648
v_mfma_f32_16x16x32_bf16 v[212:215], v[136:139], v[172:175], 0
s_add_u32 m0, s100, 20480
s_cmp_ge_u32 s92, 6
s_cselect_b32 s76, s60, s99
s_add_u32 s76, s76, 30720
buffer_load_dwordx4 v1, s[12:15], s76 offen offset:0 lds
v_mfma_f32_16x16x32_bf16 v[208:211], v[136:139], v[168:171], 0
ds_read2_b64 v[68:71], v12 offset0:72 offset1:73
v_mfma_f32_16x16x32_bf16 v[220:223], v[144:147], v[172:175], v[220:223]
ds_read_b128 v[100:103], v14 offset:3136
v_mfma_f32_16x16x32_bf16 v[216:219], v[136:139], v[176:179], v[216:219]
buffer_load_dwordx4 v1, s[12:15], s76 offen offset:1024 lds
v_mfma_f32_16x16x32_bf16 v[212:215], v[140:143], v[168:171], v[212:215]
ds_read2_b64 v[72:75], v12 offset0:136 offset1:137
v_mfma_f32_16x16x32_bf16 v[204:207], v[132:135], v[168:171], 0
ds_read_b128 v[104:107], v14 offset:2624
v_mfma_f32_16x16x32_bf16 v[220:223], v[136:139], v[180:183], v[220:223]
v_mfma_f32_16x16x32_bf16 v[216:219], v[144:147], v[168:171], v[216:219]
ds_read2_b64 v[76:79], v12 offset0:200 offset1:201
buffer_load_dwordx4 v1, s[12:15], s76 offen offset:2048 lds
v_mfma_f32_16x16x32_bf16 v[208:211], v[132:135], v[172:175], v[208:211]
ds_read_b128 v[108:111], v14 offset:2112
v_mfma_f32_16x16x32_bf16 v[212:215], v[132:135], v[176:179], v[212:215]
v_mfma_f32_16x16x32_bf16 v[220:223], v[148:151], v[168:171], v[220:223]
ds_read2_b64 v[80:83], v13 offset0:8 offset1:9
buffer_load_dwordx4 v1, s[12:15], s76 offen offset:3072 lds
v_mfma_f32_16x16x32_bf16 v[216:219], v[132:135], v[180:183], v[216:219]
ds_read_b128 v[112:115], v14 offset:1600
v_mfma_f32_16x16x32_bf16 v[200:203], v[132:135], v[164:167], 0
v_mfma_f32_16x16x32_bf16 v[204:207], v[136:139], v[164:167], v[204:207]
ds_read2_b64 v[84:87], v13 offset0:72 offset1:73
v_mfma_f32_16x16x32_bf16 v[220:223], v[132:135], v[184:187], v[220:223]
ds_read_b128 v[116:119], v14 offset:1088
s_add_u32 m0, s100, 24576
s_add_u32 s76, s76, 4096
buffer_load_dwordx4 v1, s[12:15], s76 offen offset:0 lds
v_mfma_f32_16x16x32_bf16 v[208:211], v[140:143], v[164:167], v[208:211]
v_mfma_f32_16x16x32_bf16 v[212:215], v[144:147], v[164:167], v[212:215]
ds_read2_b64 v[88:91], v13 offset0:136 offset1:137
v_mfma_f32_16x16x32_bf16 v[216:219], v[148:151], v[164:167], v[216:219]
ds_read_b128 v[120:123], v14 offset:576
v_mfma_f32_16x16x32_bf16 v[220:223], v[152:155], v[164:167], v[220:223]
s_add_u32 m0, s101, 5120
s_cmp_ge_u32 s92, 3
s_cselect_b32 s76, s60, s99
s_add_u32 s76, s76, 46080
buffer_load_dwordx4 v1, s[12:15], s76 offen offset:0 lds
v_mfma_f32_16x16x32_bf16 v[196:199], v[128:131], v[164:167], 0
ds_read2_b64 v[92:95], v13 offset0:200 offset1:201
v_mfma_f32_16x16x32_bf16 v[200:203], v[128:131], v[168:171], v[200:203]
ds_read_b128 v[124:127], v14 offset:64
v_mfma_f32_16x16x32_bf16 v[204:207], v[128:131], v[172:175], v[204:207]
buffer_load_dwordx4 v1, s[12:15], s76 offen offset:1024 lds
v_mfma_f32_16x16x32_bf16 v[208:211], v[128:131], v[176:179], v[208:211]
v_mfma_f32_16x16x32_bf16 v[212:215], v[128:131], v[180:183], v[212:215]
v_mfma_f32_16x16x32_bf16 v[216:219], v[128:131], v[184:187], v[216:219]
v_mfma_f32_16x16x32_bf16 v[220:223], v[128:131], v[188:191], v[220:223]
buffer_load_dwordx4 v1, s[12:15], s76 offen offset:2048 lds
v_mfma_f32_16x16x32_bf16 v[192:195], v[128:131], v[160:163], 0
v_mfma_f32_16x16x32_bf16 v[196:199], v[132:135], v[160:163], v[196:199]
v_mfma_f32_16x16x32_bf16 v[200:203], v[136:139], v[160:163], v[200:203]
buffer_load_dwordx4 v1, s[12:15], s76 offen offset:3072 lds
v_mfma_f32_16x16x32_bf16 v[204:207], v[140:143], v[160:163], v[204:207]
v_mfma_f32_16x16x32_bf16 v[208:211], v[144:147], v[160:163], v[208:211]
v_mfma_f32_16x16x32_bf16 v[212:215], v[148:151], v[160:163], v[212:215]
v_mfma_f32_16x16x32_bf16 v[216:219], v[152:155], v[160:163], v[216:219]
s_add_u32 m0, s101, 9216
s_add_u32 s76, s76, 4096
buffer_load_dwordx4 v1, s[12:15], s76 offen offset:0 lds
v_mfma_f32_16x16x32_bf16 v[220:223], v[156:159], v[160:163], v[220:223]
s_waitcnt lgkmcnt(0)
v_mfma_f32_16x16x32_bf16 v[220:223], v[76:79], v[112:115], v[220:223]
ds_read2_b64 v[128:131], v12 offset0:16 offset1:17
v_mfma_f32_16x16x32_bf16 v[216:219], v[76:79], v[108:111], v[216:219]
ds_read_b128 v[160:163], v14 offset:3712
v_mfma_f32_16x16x32_bf16 v[212:215], v[72:75], v[108:111], v[212:215]
v_mfma_f32_16x16x32_bf16 v[208:211], v[72:75], v[104:107], v[208:211]
ds_read2_b64 v[132:135], v12 offset0:80 offset1:81
v_mfma_f32_16x16x32_bf16 v[220:223], v[80:83], v[108:111], v[220:223]
ds_read_b128 v[164:167], v14 offset:3200
v_mfma_f32_16x16x32_bf16 v[216:219], v[72:75], v[112:115], v[216:219]
v_mfma_f32_16x16x32_bf16 v[212:215], v[76:79], v[104:107], v[212:215]
ds_read2_b64 v[136:139], v12 offset0:144 offset1:145
v_mfma_f32_16x16x32_bf16 v[204:207], v[68:71], v[104:107], v[204:207]
ds_read_b128 v[168:171], v14 offset:2688
v_mfma_f32_16x16x32_bf16 v[220:223], v[72:75], v[116:119], v[220:223]
v_mfma_f32_16x16x32_bf16 v[216:219], v[80:83], v[104:107], v[216:219]
ds_read2_b64 v[140:143], v12 offset0:208 offset1:209
v_mfma_f32_16x16x32_bf16 v[208:211], v[68:71], v[108:111], v[208:211]
ds_read_b128 v[172:175], v14 offset:2176
v_mfma_f32_16x16x32_bf16 v[212:215], v[68:71], v[112:115], v[212:215]
v_mfma_f32_16x16x32_bf16 v[220:223], v[84:87], v[104:107], v[220:223]
ds_read2_b64 v[144:147], v13 offset0:16 offset1:17
v_mfma_f32_16x16x32_bf16 v[216:219], v[68:71], v[116:119], v[216:219]
ds_read_b128 v[176:179], v14 offset:1664
v_mfma_f32_16x16x32_bf16 v[200:203], v[68:71], v[100:103], v[200:203]
v_mfma_f32_16x16x32_bf16 v[204:207], v[72:75], v[100:103], v[204:207]
ds_read2_b64 v[148:151], v13 offset0:80 offset1:81
v_mfma_f32_16x16x32_bf16 v[220:223], v[68:71], v[120:123], v[220:223]
ds_read_b128 v[180:183], v14 offset:1152
v_mfma_f32_16x16x32_bf16 v[208:211], v[76:79], v[100:103], v[208:211]
v_mfma_f32_16x16x32_bf16 v[212:215], v[80:83], v[100:103], v[212:215]
ds_read2_b64 v[152:155], v13 offset0:144 offset1:145
v_mfma_f32_16x16x32_bf16 v[216:219], v[84:87], v[100:103], v[216:219]
ds_read_b128 v[184:187], v14 offset:640
v_mfma_f32_16x16x32_bf16 v[220:223], v[88:91], v[100:103], v[220:223]
v_mfma_f32_16x16x32_bf16 v[196:199], v[64:67], v[100:103], v[196:199]
ds_read2_b64 v[156:159], v13 offset0:208 offset1:209
v_mfma_f32_16x16x32_bf16 v[200:203], v[64:67], v[104:107], v[200:203]
ds_read_b128 v[188:191], v14 offset:128
v_mfma_f32_16x16x32_bf16 v[204:207], v[64:67], v[108:111], v[204:207]
v_mfma_f32_16x16x32_bf16 v[208:211], v[64:67], v[112:115], v[208:211]
v_mfma_f32_16x16x32_bf16 v[212:215], v[64:67], v[116:119], v[212:215]
v_mfma_f32_16x16x32_bf16 v[216:219], v[64:67], v[120:123], v[216:219]
v_mfma_f32_16x16x32_bf16 v[220:223], v[64:67], v[124:127], v[220:223]
v_mfma_f32_16x16x32_bf16 v[192:195], v[64:67], v[96:99], v[192:195]
v_mfma_f32_16x16x32_bf16 v[196:199], v[68:71], v[96:99], v[196:199]
v_mfma_f32_16x16x32_bf16 v[200:203], v[72:75], v[96:99], v[200:203]
v_mfma_f32_16x16x32_bf16 v[204:207], v[76:79], v[96:99], v[204:207]
v_mfma_f32_16x16x32_bf16 v[208:211], v[80:83], v[96:99], v[208:211]
v_mfma_f32_16x16x32_bf16 v[212:215], v[84:87], v[96:99], v[212:215]
v_mfma_f32_16x16x32_bf16 v[216:219], v[88:91], v[96:99], v[216:219]
v_mfma_f32_16x16x32_bf16 v[220:223], v[92:95], v[96:99], v[220:223]
s_waitcnt lgkmcnt(0)
v_mfma_f32_16x16x32_bf16 v[220:223], v[140:143], v[176:179], v[220:223]
ds_read2_b64 v[64:67], v12 offset0:24 offset1:25
v_mfma_f32_16x16x32_bf16 v[216:219], v[140:143], v[172:175], v[216:219]
ds_read_b128 v[96:99], v14 offset:3776
v_mfma_f32_16x16x32_bf16 v[212:215], v[136:139], v[172:175], v[212:215]
s_waitcnt vmcnt(0)
ds_write_b32 v15, v15
v_mfma_f32_16x16x32_bf16 v[208:211], v[136:139], v[168:171], v[208:211]
ds_read2_b64 v[68:71], v12 offset0:88 offset1:89
v_mfma_f32_16x16x32_bf16 v[220:223], v[144:147], v[172:175], v[220:223]
ds_read_b128 v[100:103], v14 offset:3264
v_mfma_f32_16x16x32_bf16 v[216:219], v[136:139], v[176:179], v[216:219]
v_mfma_f32_16x16x32_bf16 v[212:215], v[140:143], v[168:171], v[212:215]
ds_read2_b64 v[72:75], v12 offset0:152 offset1:153
v_mfma_f32_16x16x32_bf16 v[204:207], v[132:135], v[168:171], v[204:207]
ds_read_b128 v[104:107], v14 offset:2752
v_mfma_f32_16x16x32_bf16 v[220:223], v[136:139], v[180:183], v[220:223]
v_mfma_f32_16x16x32_bf16 v[216:219], v[144:147], v[168:171], v[216:219]
ds_read2_b64 v[76:79], v12 offset0:216 offset1:217
v_mfma_f32_16x16x32_bf16 v[208:211], v[132:135], v[172:175], v[208:211]
ds_read_b128 v[108:111], v14 offset:2240
v_mfma_f32_16x16x32_bf16 v[212:215], v[132:135], v[176:179], v[212:215]
v_mfma_f32_16x16x32_bf16 v[220:223], v[148:151], v[168:171], v[220:223]
ds_read2_b64 v[80:83], v13 offset0:24 offset1:25
v_mfma_f32_16x16x32_bf16 v[216:219], v[132:135], v[180:183], v[216:219]
ds_read_b128 v[112:115], v14 offset:1728
v_mfma_f32_16x16x32_bf16 v[200:203], v[132:135], v[164:167], v[200:203]
v_mfma_f32_16x16x32_bf16 v[204:207], v[136:139], v[164:167], v[204:207]
ds_read2_b64 v[84:87], v13 offset0:88 offset1:89
v_mfma_f32_16x16x32_bf16 v[220:223], v[132:135], v[184:187], v[220:223]
ds_read_b128 v[116:119], v14 offset:1216
v_mfma_f32_16x16x32_bf16 v[208:211], v[140:143], v[164:167], v[208:211]
v_mfma_f32_16x16x32_bf16 v[212:215], v[144:147], v[164:167], v[212:215]
ds_read2_b64 v[88:91], v13 offset0:152 offset1:153
v_mfma_f32_16x16x32_bf16 v[216:219], v[148:151], v[164:167], v[216:219]
ds_read_b128 v[120:123], v14 offset:704
v_mfma_f32_16x16x32_bf16 v[220:223], v[152:155], v[164:167], v[220:223]
v_mfma_f32_16x16x32_bf16 v[196:199], v[128:131], v[164:167], v[196:199]
ds_read2_b64 v[92:95], v13 offset0:216 offset1:217
v_mfma_f32_16x16x32_bf16 v[200:203], v[128:131], v[168:171], v[200:203]
ds_read_b128 v[124:127], v14 offset:192
v_mfma_f32_16x16x32_bf16 v[204:207], v[128:131], v[172:175], v[204:207]
v_mfma_f32_16x16x32_bf16 v[208:211], v[128:131], v[176:179], v[208:211]
v_mfma_f32_16x16x32_bf16 v[212:215], v[128:131], v[180:183], v[212:215]
v_mfma_f32_16x16x32_bf16 v[216:219], v[128:131], v[184:187], v[216:219]
v_mfma_f32_16x16x32_bf16 v[220:223], v[128:131], v[188:191], v[220:223]
v_mfma_f32_16x16x32_bf16 v[192:195], v[128:131], v[160:163], v[192:195]
v_mfma_f32_16x16x32_bf16 v[196:199], v[132:135], v[160:163], v[196:199]
v_mfma_f32_16x16x32_bf16 v[200:203], v[136:139], v[160:163], v[200:203]
v_mfma_f32_16x16x32_bf16 v[204:207], v[140:143], v[160:163], v[204:207]
v_mfma_f32_16x16x32_bf16 v[208:211], v[144:147], v[160:163], v[208:211]
v_mfma_f32_16x16x32_bf16 v[212:215], v[148:151], v[160:163], v[212:215]
v_mfma_f32_16x16x32_bf16 v[216:219], v[152:155], v[160:163], v[216:219]
v_mfma_f32_16x16x32_bf16 v[220:223], v[156:159], v[160:163], v[220:223]
s_waitcnt lgkmcnt(0)
v_mfma_f32_16x16x32_bf16 v[220:223], v[76:79], v[112:115], v[220:223]
v_mfma_f32_16x16x32_bf16 v[216:219], v[76:79], v[108:111], v[216:219]
v_mfma_f32_16x16x32_bf16 v[212:215], v[72:75], v[108:111], v[212:215]
v_mfma_f32_16x16x32_bf16 v[208:211], v[72:75], v[104:107], v[208:211]
v_mfma_f32_16x16x32_bf16 v[220:223], v[80:83], v[108:111], v[220:223]
v_mfma_f32_16x16x32_bf16 v[216:219], v[72:75], v[112:115], v[216:219]
v_mfma_f32_16x16x32_bf16 v[212:215], v[76:79], v[104:107], v[212:215]
v_mfma_f32_16x16x32_bf16 v[204:207], v[68:71], v[104:107], v[204:207]
v_mfma_f32_16x16x32_bf16 v[220:223], v[72:75], v[116:119], v[220:223]
v_mfma_f32_16x16x32_bf16 v[216:219], v[80:83], v[104:107], v[216:219]
v_mfma_f32_16x16x32_bf16 v[208:211], v[68:71], v[108:111], v[208:211]
v_mfma_f32_16x16x32_bf16 v[212:215], v[68:71], v[112:115], v[212:215]
v_mfma_f32_16x16x32_bf16 v[220:223], v[84:87], v[104:107], v[220:223]
v_mfma_f32_16x16x32_bf16 v[216:219], v[68:71], v[116:119], v[216:219]
v_mfma_f32_16x16x32_bf16 v[200:203], v[68:71], v[100:103], v[200:203]
v_mfma_f32_16x16x32_bf16 v[204:207], v[72:75], v[100:103], v[204:207]
v_mfma_f32_16x16x32_bf16 v[220:223], v[68:71], v[120:123], v[220:223]
v_mfma_f32_16x16x32_bf16 v[208:211], v[76:79], v[100:103], v[208:211]
v_mfma_f32_16x16x32_bf16 v[212:215], v[80:83], v[100:103], v[212:215]
v_mfma_f32_16x16x32_bf16 v[216:219], v[84:87], v[100:103], v[216:219]
v_mfma_f32_16x16x32_bf16 v[220:223], v[88:91], v[100:103], v[220:223]
v_mfma_f32_16x16x32_bf16 v[196:199], v[64:67], v[100:103], v[196:199]
v_mfma_f32_16x16x32_bf16 v[200:203], v[64:67], v[104:107], v[200:203]
v_mfma_f32_16x16x32_bf16 v[204:207], v[64:67], v[108:111], v[204:207]
v_mfma_f32_16x16x32_bf16 v[208:211], v[64:67], v[112:115], v[208:211]
v_mfma_f32_16x16x32_bf16 v[212:215], v[64:67], v[116:119], v[212:215]
v_mfma_f32_16x16x32_bf16 v[216:219], v[64:67], v[120:123], v[216:219]
v_mfma_f32_16x16x32_bf16 v[220:223], v[64:67], v[124:127], v[220:223]
v_mfma_f32_16x16x32_bf16 v[192:195], v[64:67], v[96:99], v[192:195]
v_mfma_f32_16x16x32_bf16 v[196:199], v[68:71], v[96:99], v[196:199]
v_mfma_f32_16x16x32_bf16 v[200:203], v[72:75], v[96:99], v[200:203]
v_mfma_f32_16x16x32_bf16 v[204:207], v[76:79], v[96:99], v[204:207]
v_mfma_f32_16x16x32_bf16 v[208:211], v[80:83], v[96:99], v[208:211]
v_mfma_f32_16x16x32_bf16 v[212:215], v[84:87], v[96:99], v[212:215]
v_mfma_f32_16x16x32_bf16 v[216:219], v[88:91], v[96:99], v[216:219]
v_mfma_f32_16x16x32_bf16 v[220:223], v[92:95], v[96:99], v[220:223]
s_lshl_b32 s76, s3, 12
s_add_u32 s76, s76, 146304
s_xor_b32 s77, s3, 1
s_lshl_b32 s77, s77, 12
s_add_u32 s77, s77, 146304
v_add_u32 v4, s77, v1
v_add_u32 v5, s76, v1
s_lshl_b32 s84, s3, 2
s_add_u32 s84, s84, 163712
v_mov_b32 v6, s84
v_xor_b32 v7, 4, v6
v_mov_b32 v8, 3
v_and_b32 v9, 15, v0
v_lshlrev_b32 v9, 5, v9
v_lshrrev_b32 v10, 4, v0
v_lshl_add_u32 v9, v10, 3, v9
v_add_u32 v9, s76, v9
s_lshl_b32 s84, s83, 12
s_lshl_b32 s85, s82, 11
s_add_u32 s84, s84, s85
s_add_u32 s84, s84, 2625536
s_cmp_eq_u32 s82, 0
s_cbranch_scc0 MG1_x_h1
ds_write_b128 v4, v[208:211] offset:0
ds_write_b128 v4, v[212:215] offset:1024
ds_write_b128 v4, v[216:219] offset:2048
ds_write_b128 v4, v[220:223] offset:3072
s_waitcnt lgkmcnt(0)
ds_write_b32 v6, v8
s_branch MG1_x_j
MG1_x_h1:
ds_write_b128 v4, v[192:195] offset:0
ds_write_b128 v4, v[196:199] offset:1024
ds_write_b128 v4, v[200:203] offset:2048
ds_write_b128 v4, v[204:207] offset:3072
s_waitcnt lgkmcnt(0)
ds_write_b32 v6, v8
v_mov_b64 v[192:193], v[208:209]
v_mov_b64 v[194:195], v[210:211]
v_mov_b64 v[196:197], v[212:213]
v_mov_b64 v[198:199], v[214:215]
v_mov_b64 v[200:201], v[216:217]
v_mov_b64 v[202:203], v[218:219]
v_mov_b64 v[204:205], v[220:221]
v_mov_b64 v[206:207], v[222:223]
MG1_x_j:
s_mov_b32 s97, 0
MG1_x_sp:
ds_read_b32 v10, v7
s_add_u32 s97, s97, 1
s_waitcnt lgkmcnt(0)
v_cmp_gt_u32 vcc, 3, v10
s_cmp_ge_u32 s97, 2097152
s_cbranch_scc1 MG1_x_sp_done
s_cbranch_vccnz MG1_x_sp
MG1_x_sp_done:
ds_read_b128 v[16:19], v5 offset:0
ds_read_b128 v[20:23], v5 offset:1024
ds_read_b128 v[24:27], v5 offset:2048
ds_read_b128 v[28:31], v5 offset:3072
s_waitcnt lgkmcnt(3)
v_add_f32 v16, v16, v192
v_add_f32 v17, v17, v193
v_add_f32 v18, v18, v194
v_add_f32 v19, v19, v195
v_cvt_pk_bf16_f32 v32, v16, v17
v_cvt_pk_bf16_f32 v33, v18, v19
s_waitcnt lgkmcnt(2)
v_add_f32 v20, v20, v196
v_add_f32 v21, v21, v197
v_add_f32 v22, v22, v198
v_add_f32 v23, v23, v199
v_cvt_pk_bf16_f32 v34, v20, v21
v_cvt_pk_bf16_f32 v35, v22, v23
s_waitcnt lgkmcnt(1)
v_add_f32 v24, v24, v200
v_add_f32 v25, v25, v201
v_add_f32 v26, v26, v202
v_add_f32 v27, v27, v203
v_cvt_pk_bf16_f32 v36, v24, v25
v_cvt_pk_bf16_f32 v37, v26, v27
s_waitcnt lgkmcnt(0)
v_add_f32 v28, v28, v204
v_add_f32 v29, v29, v205
v_add_f32 v30, v30, v206
v_add_f32 v31, v31, v207
v_cvt_pk_bf16_f32 v38, v28, v29
v_cvt_pk_bf16_f32 v39, v30, v31
ds_write_b64 v9, v[32:33] offset:0
ds_write_b64 v9, v[34:35] offset:512
ds_write_b64 v9, v[36:37] offset:1024
ds_write_b64 v9, v[38:39] offset:1536
s_waitcnt lgkmcnt(0)
ds_read_b128 v[40:43], v5 offset:0
ds_read_b128 v[44:47], v5 offset:1024
s_mul_i32 s85, s83, 3277
s_lshr_b32 s85, s85, 16
s_mul_i32 s87, s85, 20
s_sub_u32 s87, s83, s87
s_lshl_b32 s88, s82, 5
s_add_u32 s85, s85, s88
s_mul_i32 s85, s85, 4352
s_lshl2_add_u32 s85, s87, s85
s_add_u32 s85, s85, 15015936
s_waitcnt lgkmcnt(1)
buffer_store_dwordx4 v[40:43], v1, s[12:15], s84 offen offset:0 sc1
s_waitcnt lgkmcnt(0)
buffer_store_dwordx4 v[44:47], v1, s[12:15], s84 offen offset:1024 sc1
v_mov_b32 v10, 0
v_mov_b32 v11, s96
s_waitcnt vmcnt(0)
buffer_store_dword v11, v10, s[12:15], s85 offen sc1
s_lshr_b32 s88, s70, 4
s_lshl_b32 s88, s88, 5
s_lshl2_add_u32 s87, s71, s3
s_add_u32 s88, s88, s87
s_mul_i32 s88, s88, 4352
s_add_u32 s86, s88, 15015936
v_min_u32 v4, 19, v0
v_lshlrev_b32 v4, 2, v4
v_bfe_u32 v5, v0, 4, 1
s_and_b32 s88, s3, 1
s_lshl_b32 s88, s88, 2
v_lshl_or_b32 v5, v5, 1, s88
v_xor_b32 v5, v5, v0
v_and_b32 v5, 7, v5
v_lshrrev_b32 v6, 3, v0
v_lshlrev_b32 v6, 12, v6
v_lshl_add_u32 v5, v5, 4, v6
s_mul_i32 s87, s87, 81920
s_lshl_b32 s88, s70, 7
s_add_u32 s87, s87, s88
s_add_u32 s87, s87, 2625536
s_add_u32 s84, s87, 31744
s_add_u32 s85, s87, 63488
s_lshl_b32 s88, s3, 12
s_add_u32 m0, s88, 146304
s_setprio 0
s_lshl_b32 s88, s3, 2
s_add_u32 s88, s88, 163744
v_mov_b32 v8, s88
s_mov_b32 s97, 0
MG1_ys:
ds_read_b32 v9, v8
s_add_u32 s97, s97, 1
s_waitcnt lgkmcnt(0)
v_cmp_gt_u32 vcc, 1, v9
s_cmp_ge_u32 s97, 2097152
s_cbranch_scc1 MG1_ys_done
s_cbranch_vccnz MG1_ys
MG1_ys_done:
s_mov_b32 s97, 0
MG1_yp_loop:
buffer_load_dword v7, v4, s[12:15], s86 offen sc1
s_add_u32 s97, s97, 1
s_waitcnt vmcnt(0)
v_cmp_ne_u32 vcc, s96, v7
s_cmp_ge_u32 s97, 32768
s_cbranch_scc1 MG1_yp_done
s_cbranch_vccnz MG1_yp_loop
MG1_yp_done:
buffer_load_dwordx4 v5, s[12:15], s87 offen lds
buffer_load_dwordx4 v5, s[12:15], s84 offen offset:1024 lds
s_mov_b32 exec_hi, 0
buffer_load_dwordx4 v5, s[12:15], s85 offen offset:2048 lds
s_mov_b64 exec, -1
s_waitcnt vmcnt(0)
s_barrier
s_endpgm
MG0:
s_and_b32 s74, s3, 1
s_lshr_b32 s75, s3, 1
s_mov_b32 s78, s3
s_mul_i32 s80, s3, 12
s_add_u32 s80, s80, s69
s_lshl_b32 s81, s68, 5
s_add_u32 s81, s81, s80
v_and_b32 v96, 15, v0
v_lshlrev_b32 v97, 4, v96
v_lshrrev_b32 v98, 4, v0
v_mul_u32_u24 v96, 1280, v98
v_add_u32 v96, v96, v97
v_and_b32 v99, 31, v0
v_lshlrev_b32 v100, 1, v99
s_lshl2_add_u32 s77, s69, s3
s_lshl_b32 s77, s77, 6
s_mul_i32 s76, s81, 5120
s_mov_b32 s6, 2621440
s_mov_b32 s7, 0x20000
s_movk_i32 s10, 1280
s_mov_b32 s11, 0x20000
s_movk_i32 s30, 3072
s_mov_b32 s31, 0x20000
s_waitcnt lgkmcnt(0)
s_mov_b32 s4, s32
s_mov_b32 s5, s33
s_mov_b32 s8, s56
s_mov_b32 s9, s57
s_mov_b32 s28, s50
s_mov_b32 s29, s51
s_load_dword s96, s[62:63], 0
s_cmp_ge_u32 s80, 32
s_cbranch_scc1 MG0_nol
buffer_load_dwordx4 v[16:19], v96, s[4:7], s76 offen offset:0
buffer_load_dwordx4 v[20:23], v96, s[4:7], s76 offen offset:256
buffer_load_dwordx4 v[24:27], v96, s[4:7], s76 offen offset:512
buffer_load_dwordx4 v[28:31], v96, s[4:7], s76 offen offset:768
buffer_load_dwordx4 v[32:35], v96, s[4:7], s76 offen offset:1024
buffer_load_dwordx4 v[36:39], v97, s[8:11], 0 offen offset:0
buffer_load_dwordx4 v[40:43], v97, s[8:11], 0 offen offset:256
buffer_load_dwordx4 v[44:47], v97, s[8:11], 0 offen offset:512
buffer_load_dwordx4 v[48:51], v97, s[8:11], 0 offen offset:768
buffer_load_dwordx4 v[52:55], v97, s[8:11], 0 offen offset:1024
MG0_nol:
buffer_load_ushort v56, v100, s[28:31], s77 offen
s_mov_b32 s16, s52
s_mov_b32 s17, s53
s_mov_b32 s18, 1966080
s_mov_b32 s19, 0x20000
s_mul_i32 s45, s64, 24
s_add_u32 s45, s45, s65
s_sub_u32 s45, s45, 8
s_lshr_b32 s44, s45, 1
s_and_b32 s45, s45, 1
s_lshl2_add_u32 s45, s45, s3
s_mul_i32 s84, s44, 20480
s_mul_i32 s85, s45, 160
s_add_u32 s84, s84, s85
s_mul_i32 s47, s3, 2560
s_add_u32 s47, s47, 146304
s_mov_b32 m0, s47
s_movk_i32 s85, 1120
v_lshlrev_b32 v1, 4, v0
v_mul_u32_u24 v154, 205, v0
v_add_u32 v155, 0, v154
v_lshrrev_b32 v155, 11, v155
v_mad_u32_u24 v155, v155, s85, v1
buffer_load_dwordx4 v155, s[16:19], s84 offen offset:0 lds
v_add_u32 v156, 13120, v154
v_lshrrev_b32 v156, 11, v156
v_mad_u32_u24 v156, v156, s85, v1
buffer_load_dwordx4 v156, s[16:19], s84 offen offset:1024 lds
v_add_u32 v157, 26240, v154
v_lshrrev_b32 v157, 11, v157
v_mad_u32_u24 v157, v157, s85, v1
s_mov_b32 exec_hi, 0
buffer_load_dwordx4 v157, s[16:19], s84 offen offset:2048 lds
s_mov_b64 exec, -1
v_lshrrev_b32 v2, 5, v0
v_bfe_u32 v3, v0, 2, 2
v_lshl_add_u32 v3, v2, 2, v3
v_mul_u32_u24 v137, 160, v3
v_bfe_u32 v3, v0, 4, 1
v_lshl_add_u32 v137, v3, 3, v137
v_and_b32 v138, 3, v0
v_mul_u32_u24 v138, 40, v138
v_add3_u32 v137, v137, v138, s47
v_lshlrev_b32 v138, 10, v3
v_lshl_add_u32 v138, v2, 8, v138
v_and_b32 v3, 15, v0
v_lshl_add_u32 v138, v3, 4, v138
s_lshr_b32 s84, s44, 1
s_mul_i32 s94, s45, 245760
s_mul_i32 s84, s84, 5120
s_add_u32 s94, s94, s84
s_and_b32 s84, s44, 1
s_lshl_b32 s84, s84, 9
s_add_u32 s94, s94, s84
s_add_u32 s94, s94, 5246976
s_add_u32 s47, s94, 4096
s_mul_i32 s84, s44, 171
s_lshr_b32 s84, s84, 12
s_lshl2_add_u32 s45, s45, s84
s_mul_i32 s84, s84, 24
s_sub_u32 s84, s44, s84
s_mul_i32 s45, s45, 4352
s_lshl2_add_u32 s45, s84, s45
s_add_u32 s45, s45, 14458880
v_mul_u32_u24 v139, 139264, v0
s_lshl_b32 s46, s2, 6
s_add_u32 s46, s46, 13537292
s_lshl_b32 s81, s81, 6
s_add_u32 s81, s81, 13504512
s_mov_b32 s95, 0x3f803f80
s_lshl_b32 s84, s3, 7
s_add_u32 s84, s84, 163200
v_lshl_add_u32 v99, v99, 2, s84
v_lshlrev_b32 v96, 4, v98
v_mov_b32 v132, 0
v_and_b32 v133, 31, v0
v_lshlrev_b32 v134, 2, v133
v_add_u32 v134, 163712, v134
ds_write_b32 v134, v132
v_lshlrev_b32 v1, 4, v0
v_add_u32 v3, 4096, v1
v_lshrrev_b32 v2, 5, v0
v_bfe_u32 v134, v0, 2, 2
v_lshl_add_u32 v135, v2, 3, v134
v_lshlrev_b32 v4, 8, v135
v_xor_b32 v134, s78, v134
v_lshl_add_u32 v4, v134, 6, v4
v_bfe_u32 v135, v0, 4, 1
v_lshl_add_u32 v4, v135, 5, v4
v_and_b32 v134, 3, v0
v_lshl_add_u32 v4, v134, 3, v4
v_xor_b32 v5, 64, v4
v_bfe_u32 v134, v0, 1, 3
v_xor_b32 v134, v134, v2
v_lshlrev_b32 v136, 7, v133
v_lshl_add_u32 v6, v134, 4, v136
s_lshl_b32 s76, s74, 13
v_add_u32 v6, s76, v6
v_xor_b32 v7, 32, v6
v_xor_b32 v8, 64, v6
v_xor_b32 v9, 96, v6
v_and_b32 v134, 15, v0
v_cmp_eq_u32 vcc, v134, v135
v_mov_b32 v136, 0x3f803f80
v_mov_b32 v80, 0
v_mov_b32 v81, 0
v_cndmask_b32 v84, 0, v136, vcc
v_cndmask_b32 v85, 0, v136, vcc
v_cndmask_b32 v86, 0, v136, vcc
v_cndmask_b32 v87, 0, v136, vcc
v_mov_b32 v82, 0
v_mov_b32 v83, 0
v_lshlrev_b32 v10, 10, v135
v_lshl_add_u32 v10, v2, 8, v10
v_lshl_add_u32 v10, v134, 4, v10
s_lshl_b32 s76, s78, 7
s_add_u32 s76, s76, 162688
v_lshlrev_b32 v11, 6, v0
v_and_b32 v11, 64, v11
v_and_b32 v134, 48, v0
v_add3_u32 v11, v11, v134, s76
v_lshlrev_b32 v131, 4, v133
s_lshl_b32 s76, s74, 10
s_add_u32 s76, s76, 146304
v_add_u32 v130, s76, v131
v_pk_mov_b32 v[164:165], v[80:81], v[80:81]
v_pk_mov_b32 v[166:167], v[80:81], v[80:81]
v_pk_mov_b32 v[168:169], v[80:81], v[80:81]
v_pk_mov_b32 v[170:171], v[80:81], v[80:81]
v_pk_mov_b32 v[172:173], v[80:81], v[80:81]
v_pk_mov_b32 v[174:175], v[80:81], v[80:81]
v_pk_mov_b32 v[176:177], v[80:81], v[80:81]
v_pk_mov_b32 v[178:179], v[80:81], v[80:81]
v_pk_mov_b32 v[180:181], v[80:81], v[80:81]
v_pk_mov_b32 v[182:183], v[80:81], v[80:81]
v_pk_mov_b32 v[184:185], v[80:81], v[80:81]
v_pk_mov_b32 v[186:187], v[80:81], v[80:81]
v_pk_mov_b32 v[188:189], v[80:81], v[80:81]
v_pk_mov_b32 v[190:191], v[80:81], v[80:81]
v_pk_mov_b32 v[192:193], v[80:81], v[80:81]
v_pk_mov_b32 v[194:195], v[80:81], v[80:81]
v_pk_mov_b32 v[196:197], v[80:81], v[80:81]
v_pk_mov_b32 v[198:199], v[80:81], v[80:81]
v_pk_mov_b32 v[200:201], v[80:81], v[80:81]
v_pk_mov_b32 v[202:203], v[80:81], v[80:81]
v_pk_mov_b32 v[204:205], v[80:81], v[80:81]
v_pk_mov_b32 v[206:207], v[80:81], v[80:81]
v_pk_mov_b32 v[208:209], v[80:81], v[80:81]
v_pk_mov_b32 v[210:211], v[80:81], v[80:81]
v_pk_mov_b32 v[212:213], v[80:81], v[80:81]
v_pk_mov_b32 v[214:215], v[80:81], v[80:81]
v_pk_mov_b32 v[216:217], v[80:81], v[80:81]
v_pk_mov_b32 v[218:219], v[80:81], v[80:81]
v_pk_mov_b32 v[220:221], v[80:81], v[80:81]
v_pk_mov_b32 v[222:223], v[80:81], v[80:81]
v_pk_mov_b32 v[224:225], v[80:81], v[80:81]
v_pk_mov_b32 v[226:227], v[80:81], v[80:81]
s_lshl1_add_u32 s77, s68, s74
s_mul_i32 s76, s77, 48
s_lshl2_add_u32 s79, s69, s78
s_add_u32 s76, s76, s79
s_xor_b32 s79, s76, 1
s_lshl_b32 s76, s76, 12
s_add_u32 s76, s76, 7213056
s_lshl_b32 s79, s79, 12
s_add_u32 s79, s79, 7213056
s_lshl_b32 s72, s77, 10
s_add_u32 s72, s72, 13504512
s_mul_i32 s82, s69, 43
s_lshr_b32 s82, s82, 7
s_mul_i32 s83, s82, 3
s_sub_u32 s83, s69, s83
s_lshl1_add_u32 s83, s83, s75
s_lshl2_add_u32 s82, s77, s82
s_mul_i32 s82, s82, 4352
s_lshl2_add_u32 s82, s83, s82
s_add_u32 s82, s82, 13553664
s_mov_b32 s73, 0
s_mov_b32 s83, 0
s_mov_b32 s86, 0x8000
s_mov_b32 s87, 0xffff0000
s_mov_b32 s20, 0xbdd2d3e8
s_mov_b32 s21, s20
v_mov_b32 v152, 0xc0135761
v_mov_b32 v153, 0xc0135761
s_mov_b32 s22, 1.0
s_mov_b32 s23, 1.0
s_mov_b32 s12, s62
s_mov_b32 s13, s63
s_mov_b32 s14, 268435456
s_mov_b32 s15, 0x20000
s_mov_b32 s16, s54
s_mov_b32 s17, s55
s_movk_i32 s18, 1280
s_mov_b32 s19, 0x20000
s_mov_b32 s24, s58
s_mov_b32 s25, s59
s_mov_b32 s26, 2621440
s_mov_b32 s27, 0x20000
v_lshrrev_b32 v12, 4, v0
v_mul_u32_u24 v12, 40, v12
v_and_b32 v13, 15, v0
v_mul_u32_u24 v15, 1280, v13
v_add_u32 v15, v15, v12
v_lshlrev_b32 v13, 4, v13
v_min_u32 v14, 23, v0
v_lshlrev_b32 v14, 2, v14
s_mul_i32 s61, s71, 160
s_lshl2_add_u32 s101, s70, s3
s_mul_i32 s100, s101, 20480
s_add_u32 s100, s100, s61
s_lshl_b32 s101, s101, 8
s_add_u32 s101, s101, 13504512
s_mul_i32 s98, s70, 196608
s_mul_i32 s85, s3, 49152
s_add_u32 s98, s98, s85
s_add_u32 s98, s98, 7213056
s_mul_i32 s99, s71, 245760
s_mul_i32 s85, s3, 12
s_add_u32 s85, s85, s92
s_mul_i32 s85, s85, 5120
s_add_u32 s99, s99, s85
s_add_u32 s99, s99, 5246976
s_sub_u32 s60, s99, 61440
s_lshr_b32 s93, s64, 1
s_lshl3_add_u32 s93, s93, s71
s_lshl2_add_u32 s93, s93, s3
s_mul_i32 s93, s93, 4352
s_add_u32 s93, s93, 14458880
s_waitcnt lgkmcnt(0)
s_add_u32 s96, s96, 0x9e3779b9
v_mov_b32 v154, s96
s_waitcnt vmcnt(0)
ds_read_b64_tr_b16 v[140:141], v137 offset:0
ds_read_b64_tr_b16 v[142:143], v137 offset:1280
ds_read_b64_tr_b16 v[144:145], v137 offset:16
ds_read_b64_tr_b16 v[146:147], v137 offset:1296
ds_read_b64_tr_b16 v[148:149], v137 offset:32
ds_read_b64_tr_b16 v[150:151], v137 offset:1312
v_lshlrev_b32 v56, 16, v56
s_cmp_ge_u32 s80, 32
ds_write_b32 v99, v56
s_cbranch_scc1 MG0_nos
v_dot2_f32_bf16 v102, v16, s95, 0
v_dot2_f32_bf16 v103, v16, v16, 0
v_dot2_f32_bf16 v104, v16, v36, 0
s_nop 0
v_dot2c_f32_bf16 v102, s95, v17
v_dot2c_f32_bf16 v103, v17, v17
v_dot2c_f32_bf16 v104, v17, v37
v_dot2c_f32_bf16 v102, s95, v18
v_dot2c_f32_bf16 v103, v18, v18
v_dot2c_f32_bf16 v104, v18, v38
v_dot2c_f32_bf16 v102, s95, v19
v_dot2c_f32_bf16 v103, v19, v19
v_dot2c_f32_bf16 v104, v19, v39
v_dot2c_f32_bf16 v102, s95, v20
v_dot2c_f32_bf16 v103, v20, v20
v_dot2c_f32_bf16 v104, v20, v40
v_dot2c_f32_bf16 v102, s95, v21
v_dot2c_f32_bf16 v103, v21, v21
v_dot2c_f32_bf16 v104, v21, v41
v_dot2c_f32_bf16 v102, s95, v22
v_dot2c_f32_bf16 v103, v22, v22
v_dot2c_f32_bf16 v104, v22, v42
v_dot2c_f32_bf16 v102, s95, v23
v_dot2c_f32_bf16 v103, v23, v23
v_dot2c_f32_bf16 v104, v23, v43
v_dot2c_f32_bf16 v102, s95, v24
v_dot2c_f32_bf16 v103, v24, v24
v_dot2c_f32_bf16 v104, v24, v44
v_dot2c_f32_bf16 v102, s95, v25
v_dot2c_f32_bf16 v103, v25, v25
v_dot2c_f32_bf16 v104, v25, v45
v_dot2c_f32_bf16 v102, s95, v26
v_dot2c_f32_bf16 v103, v26, v26
v_dot2c_f32_bf16 v104, v26, v46
v_dot2c_f32_bf16 v102, s95, v27
v_dot2c_f32_bf16 v103, v27, v27
v_dot2c_f32_bf16 v104, v27, v47
v_dot2c_f32_bf16 v102, s95, v28
v_dot2c_f32_bf16 v103, v28, v28
v_dot2c_f32_bf16 v104, v28, v48
v_dot2c_f32_bf16 v102, s95, v29
v_dot2c_f32_bf16 v103, v29, v29
v_dot2c_f32_bf16 v104, v29, v49
v_dot2c_f32_bf16 v102, s95, v30
v_dot2c_f32_bf16 v103, v30, v30
v_dot2c_f32_bf16 v104, v30, v50
v_dot2c_f32_bf16 v102, s95, v31
v_dot2c_f32_bf16 v103, v31, v31
v_dot2c_f32_bf16 v104, v31, v51
v_dot2c_f32_bf16 v102, s95, v32
v_dot2c_f32_bf16 v103, v32, v32
v_dot2c_f32_bf16 v104, v32, v52
v_dot2c_f32_bf16 v102, s95, v33
v_dot2c_f32_bf16 v103, v33, v33
v_dot2c_f32_bf16 v104, v33, v53
v_dot2c_f32_bf16 v102, s95, v34
v_dot2c_f32_bf16 v103, v34, v34
v_dot2c_f32_bf16 v104, v34, v54
v_dot2c_f32_bf16 v102, s95, v35
v_dot2c_f32_bf16 v103, v35, v35
v_dot2c_f32_bf16 v104, v35, v55
s_nop 2
v_add_f32_dpp v102, v102, v102 quad_perm:[1,0,3,2] row_mask:0xf bank_mask:0xf
v_add_f32_dpp v103, v103, v103 quad_perm:[1,0,3,2] row_mask:0xf bank_mask:0xf
v_add_f32_dpp v104, v104, v104 quad_perm:[1,0,3,2] row_mask:0xf bank_mask:0xf
v_add_f32_dpp v102, v102, v102 quad_perm:[2,3,0,1] row_mask:0xf bank_mask:0xf
v_add_f32_dpp v103, v103, v103 quad_perm:[2,3,0,1] row_mask:0xf bank_mask:0xf
v_add_f32_dpp v104, v104, v104 quad_perm:[2,3,0,1] row_mask:0xf bank_mask:0xf
v_add_f32_dpp v102, v102, v102 row_half_mirror row_mask:0xf bank_mask:0xf
v_add_f32_dpp v103, v103, v103 row_half_mirror row_mask:0xf bank_mask:0xf
v_add_f32_dpp v104, v104, v104 row_half_mirror row_mask:0xf bank_mask:0xf
v_add_f32_dpp v102, v102, v102 row_mirror row_mask:0xf bank_mask:0xf
v_add_f32_dpp v103, v103, v103 row_mirror row_mask:0xf bank_mask:0xf
v_add_f32_dpp v104, v104, v104 row_mirror row_mask:0xf bank_mask:0xf
v_mul_f32 v102, 0xbacccccd, v102
v_mul_f32 v103, 0x3acccccd, v103
v_mul_f32 v104, 0xbfb8aa3b, v104
v_fma_f32 v103, -v102, v102, v103
v_exp_f32 v104, v104
v_max_f32 v103, 0, v103
v_add_f32 v103, 0x3727c5ac, v103
v_add_f32 v104, 1.0, v104
v_rsq_f32 v106, v103
v_rcp_f32 v108, v104
v_mov_b32 v109, s96
v_mul_f32 v107, v102, v106
s_mov_b32 exec_lo, 0x00010001
s_mov_b32 exec_hi, 0x00010001
buffer_store_dwordx4 v[106:109], v96, s[12:15], s81 offen sc1
s_mov_b64 exec, -1
MG0_nos:
s_waitcnt lgkmcnt(0)
buffer_store_dwordx4 v[140:143], v138, s[12:15], s94 offen sc1
buffer_store_dwordx4 v[144:147], v138, s[12:15], s94 offen offset:2048 sc1
s_mov_b32 exec_lo, 0xffff
s_mov_b32 exec_hi, 0xffff
buffer_store_dwordx4 v[148:151], v138, s[12:15], s47 offen sc1
s_mov_b64 exec, -1
s_barrier
ds_read_b128 v[16:19], v6
ds_read_b64_tr_b16 v[24:25], v4 offset:16384
ds_read_b64_tr_b16 v[26:27], v4 offset:17408
ds_read_b128 v[20:23], v6 offset:4096
ds_read_b64_tr_b16 v[28:29], v5 offset:16384
ds_read_b64_tr_b16 v[30:31], v5 offset:17408
ds_read_b128 v[32:35], v7
ds_read_b64_tr_b16 v[40:41], v4 offset:20480
ds_read_b64_tr_b16 v[42:43], v4 offset:21504
ds_read_b128 v[36:39], v7 offset:4096
ds_read_b64_tr_b16 v[44:45], v5 offset:20480
ds_read_b64_tr_b16 v[46:47], v5 offset:21504
MG0_loop0:
s_waitcnt lgkmcnt(6)
v_mfma_f32_32x32x16_bf16 v[164:179], v[24:27], v[16:19], v[164:179]
ds_read_b128 v[48:51], v8
ds_read_b64_tr_b16 v[56:57], v4 offset:24576
v_mfma_f32_32x32x16_bf16 v[180:195], v[24:27], v[20:23], v[180:195]
ds_read_b64_tr_b16 v[58:59], v4 offset:25600
v_mfma_f32_32x32x16_bf16 v[212:227], v[28:31], v[20:23], v[212:227]
ds_read_b128 v[52:55], v8 offset:4096
v_mfma_f32_32x32x16_bf16 v[196:211], v[28:31], v[16:19], v[196:211]
ds_read_b64_tr_b16 v[60:61], v5 offset:24576
v_mfma_f32_16x16x32_bf16 v[80:83], v[24:27], v[84:87], v[80:83]
ds_read_b64_tr_b16 v[62:63], v5 offset:25600
s_waitcnt lgkmcnt(6)
v_mfma_f32_32x32x16_bf16 v[164:179], v[40:43], v[32:35], v[164:179]
ds_read_b128 v[64:67], v9
ds_read_b64_tr_b16 v[72:73], v4 offset:28672
v_mfma_f32_32x32x16_bf16 v[180:195], v[40:43], v[36:39], v[180:195]
ds_read_b64_tr_b16 v[74:75], v4 offset:29696
v_mfma_f32_32x32x16_bf16 v[212:227], v[44:47], v[36:39], v[212:227]
ds_read_b128 v[68:71], v9 offset:4096
v_mfma_f32_32x32x16_bf16 v[196:211], v[44:47], v[32:35], v[196:211]
ds_read_b64_tr_b16 v[76:77], v5 offset:28672
v_mfma_f32_16x16x32_bf16 v[80:83], v[40:43], v[84:87], v[80:83]
ds_read_b64_tr_b16 v[78:79], v5 offset:29696
s_waitcnt lgkmcnt(6)
v_mfma_f32_32x32x16_bf16 v[164:179], v[56:59], v[48:51], v[164:179]
s_add_u32 s73, s73, 1
s_add_u32 s83, s83, 1
s_cmp_eq_u32 s83, 3
s_cselect_b32 s83, 0, s83
s_cselect_b32 s85, s87, s86
v_mfma_f32_32x32x16_bf16 v[180:195], v[56:59], v[52:55], v[180:195]
v_add_u32 v4, s85, v4
v_add_u32 v5, s85, v5
v_mfma_f32_32x32x16_bf16 v[212:227], v[60:63], v[52:55], v[212:227]
v_add_u32 v6, s85, v6
v_add_u32 v7, s85, v7
v_mfma_f32_32x32x16_bf16 v[196:211], v[60:63], v[48:51], v[196:211]
v_add_u32 v8, s85, v8
v_add_u32 v9, s85, v9
v_mfma_f32_16x16x32_bf16 v[80:83], v[56:59], v[84:87], v[80:83]
s_waitcnt lgkmcnt(0)
s_barrier
v_mfma_f32_32x32x16_bf16 v[164:179], v[72:75], v[64:67], v[164:179]
ds_read_b128 v[16:19], v6
ds_read_b64_tr_b16 v[24:25], v4 offset:16384
ds_read_b64_tr_b16 v[26:27], v4 offset:17408
ds_read_b128 v[20:23], v6 offset:4096
v_mfma_f32_32x32x16_bf16 v[180:195], v[72:75], v[68:71], v[180:195]
ds_read_b64_tr_b16 v[28:29], v5 offset:16384
ds_read_b64_tr_b16 v[30:31], v5 offset:17408
ds_read_b128 v[32:35], v7
ds_read_b64_tr_b16 v[40:41], v4 offset:20480
v_mfma_f32_32x32x16_bf16 v[212:227], v[76:79], v[68:71], v[212:227]
ds_read_b64_tr_b16 v[42:43], v4 offset:21504
ds_read_b128 v[36:39], v7 offset:4096
ds_read_b64_tr_b16 v[44:45], v5 offset:20480
ds_read_b64_tr_b16 v[46:47], v5 offset:21504
v_mfma_f32_32x32x16_bf16 v[196:211], v[76:79], v[64:67], v[196:211]
v_mfma_f32_16x16x32_bf16 v[80:83], v[72:75], v[84:87], v[80:83]
s_cmp_lt_u32 s73, 2
s_cbranch_scc1 MG0_loop0
s_mov_b64 exec, 15
s_waitcnt vmcnt(0)
buffer_store_dword v154, v139, s[12:15], s45 offen sc1
s_mov_b64 exec, 1
buffer_store_dword v154, v139, s[12:15], s46 offen sc1
s_mov_b64 exec, -1
MG0_loop:
s_waitcnt lgkmcnt(6)
v_mfma_f32_32x32x16_bf16 v[164:179], v[24:27], v[16:19], v[164:179]
ds_read_b128 v[48:51], v8
ds_read_b64_tr_b16 v[56:57], v4 offset:24576
v_mfma_f32_32x32x16_bf16 v[180:195], v[24:27], v[20:23], v[180:195]
ds_read_b64_tr_b16 v[58:59], v4 offset:25600
v_mfma_f32_32x32x16_bf16 v[212:227], v[28:31], v[20:23], v[212:227]
ds_read_b128 v[52:55], v8 offset:4096
v_mfma_f32_32x32x16_bf16 v[196:211], v[28:31], v[16:19], v[196:211]
ds_read_b64_tr_b16 v[60:61], v5 offset:24576
v_mfma_f32_16x16x32_bf16 v[80:83], v[24:27], v[84:87], v[80:83]
ds_read_b64_tr_b16 v[62:63], v5 offset:25600
s_waitcnt lgkmcnt(6)
v_mfma_f32_32x32x16_bf16 v[164:179], v[40:43], v[32:35], v[164:179]
ds_read_b128 v[64:67], v9
ds_read_b64_tr_b16 v[72:73], v4 offset:28672
v_mfma_f32_32x32x16_bf16 v[180:195], v[40:43], v[36:39], v[180:195]
ds_read_b64_tr_b16 v[74:75], v4 offset:29696
v_mfma_f32_32x32x16_bf16 v[212:227], v[44:47], v[36:39], v[212:227]
ds_read_b128 v[68:71], v9 offset:4096
v_mfma_f32_32x32x16_bf16 v[196:211], v[44:47], v[32:35], v[196:211]
ds_read_b64_tr_b16 v[76:77], v5 offset:28672
v_mfma_f32_16x16x32_bf16 v[80:83], v[40:43], v[84:87], v[80:83]
ds_read_b64_tr_b16 v[78:79], v5 offset:29696
s_waitcnt lgkmcnt(6)
v_mfma_f32_32x32x16_bf16 v[164:179], v[56:59], v[48:51], v[164:179]
s_add_u32 s73, s73, 1
s_add_u32 s83, s83, 1
s_cmp_eq_u32 s83, 3
s_cselect_b32 s83, 0, s83
s_cselect_b32 s85, s87, s86
v_mfma_f32_32x32x16_bf16 v[180:195], v[56:59], v[52:55], v[180:195]
v_add_u32 v4, s85, v4
v_add_u32 v5, s85, v5
v_mfma_f32_32x32x16_bf16 v[212:227], v[60:63], v[52:55], v[212:227]
v_add_u32 v6, s85, v6
v_add_u32 v7, s85, v7
v_mfma_f32_32x32x16_bf16 v[196:211], v[60:63], v[48:51], v[196:211]
v_add_u32 v8, s85, v8
v_add_u32 v9, s85, v9
v_mfma_f32_16x16x32_bf16 v[80:83], v[56:59], v[84:87], v[80:83]
s_waitcnt lgkmcnt(0)
s_barrier
v_mfma_f32_32x32x16_bf16 v[164:179], v[72:75], v[64:67], v[164:179]
ds_read_b128 v[16:19], v6
ds_read_b64_tr_b16 v[24:25], v4 offset:16384
ds_read_b64_tr_b16 v[26:27], v4 offset:17408
ds_read_b128 v[20:23], v6 offset:4096
v_mfma_f32_32x32x16_bf16 v[180:195], v[72:75], v[68:71], v[180:195]
ds_read_b64_tr_b16 v[28:29], v5 offset:16384
ds_read_b64_tr_b16 v[30:31], v5 offset:17408
ds_read_b128 v[32:35], v7
ds_read_b64_tr_b16 v[40:41], v4 offset:20480
v_mfma_f32_32x32x16_bf16 v[212:227], v[76:79], v[68:71], v[212:227]
ds_read_b64_tr_b16 v[42:43], v4 offset:21504
ds_read_b128 v[36:39], v7 offset:4096
ds_read_b64_tr_b16 v[44:45], v5 offset:20480
ds_read_b64_tr_b16 v[46:47], v5 offset:21504
v_mfma_f32_32x32x16_bf16 v[196:211], v[76:79], v[64:67], v[196:211]
v_mfma_f32_16x16x32_bf16 v[80:83], v[72:75], v[84:87], v[80:83]
s_cmp_lt_u32 s73, 9
s_cbranch_scc1 MG0_loop
s_waitcnt lgkmcnt(6)
v_mfma_f32_32x32x16_bf16 v[164:179], v[24:27], v[16:19], v[164:179]
ds_read_b128 v[48:51], v8
ds_read_b64_tr_b16 v[56:57], v4 offset:24576
v_mfma_f32_32x32x16_bf16 v[180:195], v[24:27], v[20:23], v[180:195]
ds_read_b64_tr_b16 v[58:59], v4 offset:25600
v_mfma_f32_32x32x16_bf16 v[212:227], v[28:31], v[20:23], v[212:227]
ds_read_b128 v[52:55], v8 offset:4096
v_mfma_f32_32x32x16_bf16 v[196:211], v[28:31], v[16:19], v[196:211]
ds_read_b64_tr_b16 v[60:61], v5 offset:24576
v_mfma_f32_16x16x32_bf16 v[80:83], v[24:27], v[84:87], v[80:83]
ds_read_b64_tr_b16 v[62:63], v5 offset:25600
s_waitcnt lgkmcnt(6)
v_mfma_f32_32x32x16_bf16 v[164:179], v[40:43], v[32:35], v[164:179]
ds_read_b128 v[64:67], v9
ds_read_b64_tr_b16 v[72:73], v4 offset:28672
v_mfma_f32_32x32x16_bf16 v[180:195], v[40:43], v[36:39], v[180:195]
ds_read_b64_tr_b16 v[74:75], v4 offset:29696
v_mfma_f32_32x32x16_bf16 v[212:227], v[44:47], v[36:39], v[212:227]
ds_read_b128 v[68:71], v9 offset:4096
v_mfma_f32_32x32x16_bf16 v[196:211], v[44:47], v[32:35], v[196:211]
ds_read_b64_tr_b16 v[76:77], v5 offset:28672
v_mfma_f32_16x16x32_bf16 v[80:83], v[40:43], v[84:87], v[80:83]
ds_read_b64_tr_b16 v[78:79], v5 offset:29696
s_waitcnt lgkmcnt(6)
v_mfma_f32_32x32x16_bf16 v[164:179], v[56:59], v[48:51], v[164:179]
v_mfma_f32_32x32x16_bf16 v[180:195], v[56:59], v[52:55], v[180:195]
v_mfma_f32_32x32x16_bf16 v[212:227], v[60:63], v[52:55], v[212:227]
v_mfma_f32_32x32x16_bf16 v[196:211], v[60:63], v[48:51], v[196:211]
v_mfma_f32_16x16x32_bf16 v[80:83], v[56:59], v[84:87], v[80:83]
s_waitcnt lgkmcnt(0)
v_mfma_f32_16x16x32_bf16 v[80:83], v[72:75], v[84:87], v[80:83]
v_mfma_f32_32x32x16_bf16 v[164:179], v[72:75], v[64:67], v[164:179]
v_mfma_f32_32x32x16_bf16 v[180:195], v[72:75], v[68:71], v[180:195]
v_mfma_f32_32x32x16_bf16 v[212:227], v[76:79], v[68:71], v[212:227]
s_mov_b32 exec_lo, 0x00030003
s_mov_b32 exec_hi, 0x00030003
ds_write_b128 v11, v[80:83]
s_mov_b64 exec, -1
v_mfma_f32_32x32x16_bf16 v[196:211], v[76:79], v[64:67], v[196:211]
s_lshl_b32 s85, s78, 7
s_add_u32 s85, s85, 162688
v_lshl_add_u32 v4, v2, 4, s85
s_xor_b32 s85, s78, 1
s_lshl_b32 s85, s85, 7
s_add_u32 s85, s85, 162688
v_lshl_add_u32 v5, v2, 4, s85
s_waitcnt lgkmcnt(0)
s_barrier
v_mov_b32 v155, v131
ds_read_b128 v[156:159], v130 offset:0
ds_read_b128 v[160:163], v130 offset:512
ds_read_b128 v[228:231], v4 offset:64
ds_read_b128 v[232:235], v4 offset:96
ds_read_b128 v[236:239], v4 offset:576
ds_read_b128 v[240:243], v4 offset:608
s_waitcnt lgkmcnt(4)
ds_read_b128 v[116:119], v4 offset:0
ds_read_b128 v[120:123], v4 offset:32
ds_read_b128 v[124:127], v4 offset:512
ds_read_b128 v[128:131], v4 offset:544
s_mov_b32 s97, 0
v_cmp_ne_u32 vcc, s96, v159
v_cmp_ne_u32 s[88:89], s96, v163
s_or_b64 vcc, vcc, s[88:89]
s_nop 1
s_cbranch_vccz MG0_sp_done
MG0_sp_loop:
buffer_load_dwordx4 v[156:159], v155, s[12:15], s72 offen offset:0 sc1
buffer_load_dwordx4 v[160:163], v155, s[12:15], s72 offen offset:512 sc1
s_add_u32 s97, s97, 1
s_waitcnt vmcnt(0)
v_cmp_ne_u32 vcc, s96, v159
v_cmp_ne_u32 s[88:89], s96, v163
s_or_b64 vcc, vcc, s[88:89]
s_cmp_ge_u32 s97, 32768
s_cbranch_scc1 MG0_sp_done
s_cbranch_vccnz MG0_sp_loop
MG0_sp_done:
v_mov_b32 v144, v156
v_mov_b32 v145, v156
v_mov_b32 v146, v157
v_mov_b32 v147, v157
v_mov_b32 v148, v160
v_mov_b32 v149, v160
v_mov_b32 v150, v161
v_mov_b32 v151, v161
s_waitcnt lgkmcnt(0)
v_pk_fma_f32 v[132:133], v[116:117], v[146:147], v[124:125]
v_pk_fma_f32 v[134:135], v[118:119], v[146:147], v[126:127]
v_pk_fma_f32 v[136:137], v[120:121], v[146:147], v[128:129]
v_pk_fma_f32 v[138:139], v[122:123], v[146:147], v[130:131]
s_cmp_ge_u32 s92, 12
s_cselect_b32 s81, s60, s99
s_add_u32 s81, s81, 0
buffer_load_dwordx4 v[16:19], v1, s[12:15], s81 offen offset:0
v_pk_fma_f32 v[164:165], v[164:165], v[144:145], v[132:133]
v_pk_fma_f32 v[166:167], v[166:167], v[144:145], v[134:135]
v_pk_fma_f32 v[168:169], v[168:169], v[144:145], v[136:137]
v_pk_fma_f32 v[170:171], v[170:171], v[144:145], v[138:139]
v_pk_mul_f32 v[132:133], v[164:165], v[164:165]
v_pk_mul_f32 v[134:135], v[166:167], v[166:167]
v_pk_mul_f32 v[136:137], v[168:169], v[168:169]
v_pk_mul_f32 v[138:139], v[170:171], v[170:171]
buffer_load_dwordx4 v[20:23], v1, s[12:15], s81 offen offset:1024
v_pk_fma_f32 v[132:133], v[132:133], s[20:21], v[152:153]
v_pk_fma_f32 v[134:135], v[134:135], s[20:21], v[152:153]
v_pk_fma_f32 v[136:137], v[136:137], s[20:21], v[152:153]
v_pk_fma_f32 v[138:139], v[138:139], s[20:21], v[152:153]
v_pk_mul_f32 v[132:133], v[132:133], v[164:165]
v_pk_mul_f32 v[134:135], v[134:135], v[166:167]
v_pk_mul_f32 v[136:137], v[136:137], v[168:169]
v_pk_mul_f32 v[138:139], v[138:139], v[170:171]
v_exp_f32 v132, v132
v_exp_f32 v133, v133
v_exp_f32 v134, v134
v_exp_f32 v135, v135
buffer_load_dwordx4 v[24:27], v1, s[12:15], s81 offen offset:2048
v_exp_f32 v136, v136
v_exp_f32 v137, v137
v_exp_f32 v138, v138
v_exp_f32 v139, v139
v_pk_add_f32 v[132:133], v[132:133], s[22:23]
v_pk_add_f32 v[134:135], v[134:135], s[22:23]
v_pk_add_f32 v[136:137], v[136:137], s[22:23]
v_pk_add_f32 v[138:139], v[138:139], s[22:23]
buffer_load_dwordx4 v[28:31], v1, s[12:15], s81 offen offset:3072
v_rcp_f32 v132, v132
v_rcp_f32 v133, v133
v_rcp_f32 v134, v134
v_rcp_f32 v135, v135
v_rcp_f32 v136, v136
v_rcp_f32 v137, v137
v_rcp_f32 v138, v138
v_rcp_f32 v139, v139
v_pk_mul_f32 v[132:133], v[132:133], v[164:165]
v_pk_mul_f32 v[134:135], v[134:135], v[166:167]
v_pk_mul_f32 v[136:137], v[136:137], v[168:169]
v_pk_mul_f32 v[138:139], v[138:139], v[170:171]
v_cvt_pk_bf16_f32 v164, v132, v133
v_cvt_pk_bf16_f32 v165, v134, v135
v_cvt_pk_bf16_f32 v166, v136, v137
v_cvt_pk_bf16_f32 v167, v138, v139
buffer_store_dwordx4 v[164:167], v10, s[12:15], s76 offen offset:0 sc1
v_pk_fma_f32 v[132:133], v[116:117], v[150:151], v[124:125]
v_pk_fma_f32 v[134:135], v[118:119], v[150:151], v[126:127]
v_pk_fma_f32 v[136:137], v[120:121], v[150:151], v[128:129]
v_pk_fma_f32 v[138:139], v[122:123], v[150:151], v[130:131]
buffer_load_dwordx4 v[32:35], v3, s[12:15], s81 offen offset:0
v_pk_fma_f32 v[180:181], v[180:181], v[148:149], v[132:133]
v_pk_fma_f32 v[182:183], v[182:183], v[148:149], v[134:135]
v_pk_fma_f32 v[184:185], v[184:185], v[148:149], v[136:137]
v_pk_fma_f32 v[186:187], v[186:187], v[148:149], v[138:139]
ds_read_b128 v[116:119], v5 offset:0
ds_read_b128 v[120:123], v5 offset:32
ds_read_b128 v[124:127], v5 offset:512
ds_read_b128 v[128:131], v5 offset:544
s_cmp_ge_u32 s92, 11
s_cselect_b32 s81, s60, s99
s_add_u32 s81, s81, 5120
buffer_load_dwordx4 v[36:39], v1, s[12:15], s81 offen offset:0
v_pk_mul_f32 v[132:133], v[180:181], v[180:181]
v_pk_mul_f32 v[134:135], v[182:183], v[182:183]
v_pk_mul_f32 v[136:137], v[184:185], v[184:185]
v_pk_mul_f32 v[138:139], v[186:187], v[186:187]
v_pk_fma_f32 v[132:133], v[132:133], s[20:21], v[152:153]
v_pk_fma_f32 v[134:135], v[134:135], s[20:21], v[152:153]
v_pk_fma_f32 v[136:137], v[136:137], s[20:21], v[152:153]
v_pk_fma_f32 v[138:139], v[138:139], s[20:21], v[152:153]
v_pk_mul_f32 v[132:133], v[132:133], v[180:181]
v_pk_mul_f32 v[134:135], v[134:135], v[182:183]
v_pk_mul_f32 v[136:137], v[136:137], v[184:185]
v_pk_mul_f32 v[138:139], v[138:139], v[186:187]
buffer_load_dwordx4 v[40:43], v1, s[12:15], s81 offen offset:1024
v_exp_f32 v132, v132
v_exp_f32 v133, v133
v_exp_f32 v134, v134
v_exp_f32 v135, v135
v_exp_f32 v136, v136
v_exp_f32 v137, v137
v_exp_f32 v138, v138
v_exp_f32 v139, v139
v_pk_add_f32 v[132:133], v[132:133], s[22:23]
v_pk_add_f32 v[134:135], v[134:135], s[22:23]
v_pk_add_f32 v[136:137], v[136:137], s[22:23]
v_pk_add_f32 v[138:139], v[138:139], s[22:23]
buffer_load_dwordx4 v[44:47], v1, s[12:15], s81 offen offset:2048
v_rcp_f32 v132, v132
v_rcp_f32 v133, v133
v_rcp_f32 v134, v134
v_rcp_f32 v135, v135
v_rcp_f32 v136, v136
v_rcp_f32 v137, v137
v_rcp_f32 v138, v138
v_rcp_f32 v139, v139
v_pk_mul_f32 v[132:133], v[132:133], v[180:181]
v_pk_mul_f32 v[134:135], v[134:135], v[182:183]
v_pk_mul_f32 v[136:137], v[136:137], v[184:185]
v_pk_mul_f32 v[138:139], v[138:139], v[186:187]
v_cvt_pk_bf16_f32 v180, v132, v133
v_cvt_pk_bf16_f32 v181, v134, v135
v_cvt_pk_bf16_f32 v182, v136, v137
v_cvt_pk_bf16_f32 v183, v138, v139
buffer_store_dwordx4 v[180:183], v10, s[12:15], s76 offen offset:2048 sc1
v_pk_fma_f32 v[132:133], v[228:229], v[146:147], v[236:237]
v_pk_fma_f32 v[134:135], v[230:231], v[146:147], v[238:239]
v_pk_fma_f32 v[136:137], v[232:233], v[146:147], v[240:241]
v_pk_fma_f32 v[138:139], v[234:235], v[146:147], v[242:243]
buffer_load_dwordx4 v[48:51], v1, s[12:15], s81 offen offset:3072
v_pk_fma_f32 v[172:173], v[172:173], v[144:145], v[132:133]
v_pk_fma_f32 v[174:175], v[174:175], v[144:145], v[134:135]
v_pk_fma_f32 v[176:177], v[176:177], v[144:145], v[136:137]
v_pk_fma_f32 v[178:179], v[178:179], v[144:145], v[138:139]
v_pk_mul_f32 v[132:133], v[172:173], v[172:173]
v_pk_mul_f32 v[134:135], v[174:175], v[174:175]
v_pk_mul_f32 v[136:137], v[176:177], v[176:177]
v_pk_mul_f32 v[138:139], v[178:179], v[178:179]
buffer_load_dwordx4 v[52:55], v3, s[12:15], s81 offen offset:0
v_pk_fma_f32 v[132:133], v[132:133], s[20:21], v[152:153]
v_pk_fma_f32 v[134:135], v[134:135], s[20:21], v[152:153]
v_pk_fma_f32 v[136:137], v[136:137], s[20:21], v[152:153]
v_pk_fma_f32 v[138:139], v[138:139], s[20:21], v[152:153]
v_pk_mul_f32 v[132:133], v[132:133], v[172:173]
v_pk_mul_f32 v[134:135], v[134:135], v[174:175]
v_pk_mul_f32 v[136:137], v[136:137], v[176:177]
v_pk_mul_f32 v[138:139], v[138:139], v[178:179]
v_exp_f32 v132, v132
v_exp_f32 v133, v133
v_exp_f32 v134, v134
v_exp_f32 v135, v135
s_cmp_ge_u32 s92, 10
s_cselect_b32 s81, s60, s99
s_add_u32 s81, s81, 10240
buffer_load_dwordx4 v[56:59], v1, s[12:15], s81 offen offset:0
v_exp_f32 v136, v136
v_exp_f32 v137, v137
v_exp_f32 v138, v138
v_exp_f32 v139, v139
v_pk_add_f32 v[132:133], v[132:133], s[22:23]
v_pk_add_f32 v[134:135], v[134:135], s[22:23]
v_pk_add_f32 v[136:137], v[136:137], s[22:23]
v_pk_add_f32 v[138:139], v[138:139], s[22:23]
buffer_load_dwordx4 v[60:63], v1, s[12:15], s81 offen offset:1024
v_rcp_f32 v132, v132
v_rcp_f32 v133, v133
v_rcp_f32 v134, v134
v_rcp_f32 v135, v135
v_rcp_f32 v136, v136
v_rcp_f32 v137, v137
v_rcp_f32 v138, v138
v_rcp_f32 v139, v139
v_pk_mul_f32 v[132:133], v[132:133], v[172:173]
v_pk_mul_f32 v[134:135], v[134:135], v[174:175]
v_pk_mul_f32 v[136:137], v[136:137], v[176:177]
v_pk_mul_f32 v[138:139], v[138:139], v[178:179]
v_cvt_pk_bf16_f32 v172, v132, v133
v_cvt_pk_bf16_f32 v173, v134, v135
v_cvt_pk_bf16_f32 v174, v136, v137
v_cvt_pk_bf16_f32 v175, v138, v139
buffer_store_dwordx4 v[172:175], v10, s[12:15], s76 offen offset:512 sc1
v_pk_fma_f32 v[132:133], v[228:229], v[150:151], v[236:237]
v_pk_fma_f32 v[134:135], v[230:231], v[150:151], v[238:239]
v_pk_fma_f32 v[136:137], v[232:233], v[150:151], v[240:241]
v_pk_fma_f32 v[138:139], v[234:235], v[150:151], v[242:243]
buffer_load_dwordx4 v[64:67], v1, s[12:15], s81 offen offset:2048
v_pk_fma_f32 v[188:189], v[188:189], v[148:149], v[132:133]
v_pk_fma_f32 v[190:191], v[190:191], v[148:149], v[134:135]
v_pk_fma_f32 v[192:193], v[192:193], v[148:149], v[136:137]
v_pk_fma_f32 v[194:195], v[194:195], v[148:149], v[138:139]
ds_read_b128 v[228:231], v5 offset:64
ds_read_b128 v[232:235], v5 offset:96
ds_read_b128 v[236:239], v5 offset:576
ds_read_b128 v[240:243], v5 offset:608
buffer_load_dwordx4 v[68:71], v1, s[12:15], s81 offen offset:3072
v_pk_mul_f32 v[132:133], v[188:189], v[188:189]
v_pk_mul_f32 v[134:135], v[190:191], v[190:191]
v_pk_mul_f32 v[136:137], v[192:193], v[192:193]
v_pk_mul_f32 v[138:139], v[194:195], v[194:195]
v_pk_fma_f32 v[132:133], v[132:133], s[20:21], v[152:153]
v_pk_fma_f32 v[134:135], v[134:135], s[20:21], v[152:153]
v_pk_fma_f32 v[136:137], v[136:137], s[20:21], v[152:153]
v_pk_fma_f32 v[138:139], v[138:139], s[20:21], v[152:153]
v_pk_mul_f32 v[132:133], v[132:133], v[188:189]
v_pk_mul_f32 v[134:135], v[134:135], v[190:191]
v_pk_mul_f32 v[136:137], v[136:137], v[192:193]
v_pk_mul_f32 v[138:139], v[138:139], v[194:195]
buffer_load_dwordx4 v[72:75], v3, s[12:15], s81 offen offset:0
v_exp_f32 v132, v132
v_exp_f32 v133, v133
v_exp_f32 v134, v134
v_exp_f32 v135, v135
v_exp_f32 v136, v136
v_exp_f32 v137, v137
v_exp_f32 v138, v138
v_exp_f32 v139, v139
v_pk_add_f32 v[132:133], v[132:133], s[22:23]
v_pk_add_f32 v[134:135], v[134:135], s[22:23]
v_pk_add_f32 v[136:137], v[136:137], s[22:23]
v_pk_add_f32 v[138:139], v[138:139], s[22:23]
s_cmp_ge_u32 s92, 9
s_cselect_b32 s81, s60, s99
s_add_u32 s81, s81, 15360
buffer_load_dwordx4 v[76:79], v1, s[12:15], s81 offen offset:0
v_rcp_f32 v132, v132
v_rcp_f32 v133, v133
v_rcp_f32 v134, v134
v_rcp_f32 v135, v135
v_rcp_f32 v136, v136
v_rcp_f32 v137, v137
v_rcp_f32 v138, v138
v_rcp_f32 v139, v139
v_pk_mul_f32 v[132:133], v[132:133], v[188:189]
v_pk_mul_f32 v[134:135], v[134:135], v[190:191]
v_pk_mul_f32 v[136:137], v[136:137], v[192:193]
v_pk_mul_f32 v[138:139], v[138:139], v[194:195]
v_cvt_pk_bf16_f32 v188, v132, v133
v_cvt_pk_bf16_f32 v189, v134, v135
v_cvt_pk_bf16_f32 v190, v136, v137
v_cvt_pk_bf16_f32 v191, v138, v139
buffer_store_dwordx4 v[188:191], v10, s[12:15], s76 offen offset:2560 sc1
s_waitcnt lgkmcnt(4)
v_pk_fma_f32 v[132:133], v[116:117], v[146:147], v[124:125]
v_pk_fma_f32 v[134:135], v[118:119], v[146:147], v[126:127]
v_pk_fma_f32 v[136:137], v[120:121], v[146:147], v[128:129]
v_pk_fma_f32 v[138:139], v[122:123], v[146:147], v[130:131]
buffer_load_dwordx4 v[80:83], v1, s[12:15], s81 offen offset:1024
v_pk_fma_f32 v[196:197], v[196:197], v[144:145], v[132:133]
v_pk_fma_f32 v[198:199], v[198:199], v[144:145], v[134:135]
v_pk_fma_f32 v[200:201], v[200:201], v[144:145], v[136:137]
v_pk_fma_f32 v[202:203], v[202:203], v[144:145], v[138:139]
v_pk_mul_f32 v[132:133], v[196:197], v[196:197]
v_pk_mul_f32 v[134:135], v[198:199], v[198:199]
v_pk_mul_f32 v[136:137], v[200:201], v[200:201]
v_pk_mul_f32 v[138:139], v[202:203], v[202:203]
v_pk_fma_f32 v[132:133], v[132:133], s[20:21], v[152:153]
v_pk_fma_f32 v[134:135], v[134:135], s[20:21], v[152:153]
v_pk_fma_f32 v[136:137], v[136:137], s[20:21], v[152:153]
v_pk_fma_f32 v[138:139], v[138:139], s[20:21], v[152:153]
buffer_load_dwordx4 v[84:87], v1, s[12:15], s81 offen offset:2048
v_pk_mul_f32 v[132:133], v[132:133], v[196:197]
v_pk_mul_f32 v[134:135], v[134:135], v[198:199]
v_pk_mul_f32 v[136:137], v[136:137], v[200:201]
v_pk_mul_f32 v[138:139], v[138:139], v[202:203]
v_exp_f32 v132, v132
v_exp_f32 v133, v133
v_exp_f32 v134, v134
v_exp_f32 v135, v135
v_exp_f32 v136, v136
v_exp_f32 v137, v137
v_exp_f32 v138, v138
v_exp_f32 v139, v139
buffer_load_dwordx4 v[88:91], v1, s[12:15], s81 offen offset:3072
v_pk_add_f32 v[132:133], v[132:133], s[22:23]
v_pk_add_f32 v[134:135], v[134:135], s[22:23]
v_pk_add_f32 v[136:137], v[136:137], s[22:23]
v_pk_add_f32 v[138:139], v[138:139], s[22:23]
v_rcp_f32 v132, v132
v_rcp_f32 v133, v133
v_rcp_f32 v134, v134
v_rcp_f32 v135, v135
v_rcp_f32 v136, v136
v_rcp_f32 v137, v137
v_rcp_f32 v138, v138
v_rcp_f32 v139, v139
v_pk_mul_f32 v[132:133], v[132:133], v[196:197]
v_pk_mul_f32 v[134:135], v[134:135], v[198:199]
v_pk_mul_f32 v[136:137], v[136:137], v[200:201]
v_pk_mul_f32 v[138:139], v[138:139], v[202:203]
v_cvt_pk_bf16_f32 v196, v132, v133
v_cvt_pk_bf16_f32 v197, v134, v135
v_cvt_pk_bf16_f32 v198, v136, v137
v_cvt_pk_bf16_f32 v199, v138, v139
buffer_store_dwordx4 v[196:199], v10, s[12:15], s79 offen offset:0 sc1
v_pk_fma_f32 v[132:133], v[116:117], v[150:151], v[124:125]
v_pk_fma_f32 v[134:135], v[118:119], v[150:151], v[126:127]
v_pk_fma_f32 v[136:137], v[120:121], v[150:151], v[128:129]
v_pk_fma_f32 v[138:139], v[122:123], v[150:151], v[130:131]
buffer_load_dwordx4 v[92:95], v3, s[12:15], s81 offen offset:0
v_pk_fma_f32 v[212:213], v[212:213], v[148:149], v[132:133]
v_pk_fma_f32 v[214:215], v[214:215], v[148:149], v[134:135]
v_pk_fma_f32 v[216:217], v[216:217], v[148:149], v[136:137]
v_pk_fma_f32 v[218:219], v[218:219], v[148:149], v[138:139]
v_pk_mul_f32 v[132:133], v[212:213], v[212:213]
v_pk_mul_f32 v[134:135], v[214:215], v[214:215]
v_pk_mul_f32 v[136:137], v[216:217], v[216:217]
v_pk_mul_f32 v[138:139], v[218:219], v[218:219]
v_pk_fma_f32 v[132:133], v[132:133], s[20:21], v[152:153]
v_pk_fma_f32 v[134:135], v[134:135], s[20:21], v[152:153]
v_pk_fma_f32 v[136:137], v[136:137], s[20:21], v[152:153]
v_pk_fma_f32 v[138:139], v[138:139], s[20:21], v[152:153]
s_cmp_ge_u32 s92, 8
s_cselect_b32 s81, s60, s99
s_add_u32 s81, s81, 20480
buffer_load_dwordx4 v[96:99], v1, s[12:15], s81 offen offset:0
v_pk_mul_f32 v[132:133], v[132:133], v[212:213]
v_pk_mul_f32 v[134:135], v[134:135], v[214:215]
v_pk_mul_f32 v[136:137], v[136:137], v[216:217]
v_pk_mul_f32 v[138:139], v[138:139], v[218:219]
v_exp_f32 v132, v132
v_exp_f32 v133, v133
v_exp_f32 v134, v134
v_exp_f32 v135, v135
v_exp_f32 v136, v136
v_exp_f32 v137, v137
v_exp_f32 v138, v138
v_exp_f32 v139, v139
buffer_load_dwordx4 v[100:103], v1, s[12:15], s81 offen offset:1024
v_pk_add_f32 v[132:133], v[132:133], s[22:23]
v_pk_add_f32 v[134:135], v[134:135], s[22:23]
v_pk_add_f32 v[136:137], v[136:137], s[22:23]
v_pk_add_f32 v[138:139], v[138:139], s[22:23]
v_rcp_f32 v132, v132
v_rcp_f32 v133, v133
v_rcp_f32 v134, v134
v_rcp_f32 v135, v135
v_rcp_f32 v136, v136
v_rcp_f32 v137, v137
v_rcp_f32 v138, v138
v_rcp_f32 v139, v139
v_pk_mul_f32 v[132:133], v[132:133], v[212:213]
v_pk_mul_f32 v[134:135], v[134:135], v[214:215]
v_pk_mul_f32 v[136:137], v[136:137], v[216:217]
v_pk_mul_f32 v[138:139], v[138:139], v[218:219]
v_cvt_pk_bf16_f32 v212, v132, v133
v_cvt_pk_bf16_f32 v213, v134, v135
v_cvt_pk_bf16_f32 v214, v136, v137
v_cvt_pk_bf16_f32 v215, v138, v139
buffer_store_dwordx4 v[212:215], v10, s[12:15], s79 offen offset:2048 sc1
s_waitcnt lgkmcnt(0)
v_pk_fma_f32 v[132:133], v[228:229], v[146:147], v[236:237]
v_pk_fma_f32 v[134:135], v[230:231], v[146:147], v[238:239]
v_pk_fma_f32 v[136:137], v[232:233], v[146:147], v[240:241]
v_pk_fma_f32 v[138:139], v[234:235], v[146:147], v[242:243]
buffer_load_dwordx4 v[104:107], v1, s[12:15], s81 offen offset:2048
v_pk_fma_f32 v[204:205], v[204:205], v[144:145], v[132:133]
v_pk_fma_f32 v[206:207], v[206:207], v[144:145], v[134:135]
v_pk_fma_f32 v[208:209], v[208:209], v[144:145], v[136:137]
v_pk_fma_f32 v[210:211], v[210:211], v[144:145], v[138:139]
v_pk_mul_f32 v[132:133], v[204:205], v[204:205]
v_pk_mul_f32 v[134:135], v[206:207], v[206:207]
v_pk_mul_f32 v[136:137], v[208:209], v[208:209]
v_pk_mul_f32 v[138:139], v[210:211], v[210:211]
v_pk_fma_f32 v[132:133], v[132:133], s[20:21], v[152:153]
v_pk_fma_f32 v[134:135], v[134:135], s[20:21], v[152:153]
v_pk_fma_f32 v[136:137], v[136:137], s[20:21], v[152:153]
v_pk_fma_f32 v[138:139], v[138:139], s[20:21], v[152:153]
buffer_load_dwordx4 v[108:111], v1, s[12:15], s81 offen offset:3072
v_pk_mul_f32 v[132:133], v[132:133], v[204:205]
v_pk_mul_f32 v[134:135], v[134:135], v[206:207]
v_pk_mul_f32 v[136:137], v[136:137], v[208:209]
v_pk_mul_f32 v[138:139], v[138:139], v[210:211]
v_exp_f32 v132, v132
v_exp_f32 v133, v133
v_exp_f32 v134, v134
v_exp_f32 v135, v135
v_exp_f32 v136, v136
v_exp_f32 v137, v137
v_exp_f32 v138, v138
v_exp_f32 v139, v139
buffer_load_dwordx4 v[112:115], v3, s[12:15], s81 offen offset:0
v_pk_add_f32 v[132:133], v[132:133], s[22:23]
v_pk_add_f32 v[134:135], v[134:135], s[22:23]
v_pk_add_f32 v[136:137], v[136:137], s[22:23]
v_pk_add_f32 v[138:139], v[138:139], s[22:23]
v_rcp_f32 v132, v132
v_rcp_f32 v133, v133
v_rcp_f32 v134, v134
v_rcp_f32 v135, v135
v_rcp_f32 v136, v136
v_rcp_f32 v137, v137
v_rcp_f32 v138, v138
v_rcp_f32 v139, v139
v_pk_mul_f32 v[132:133], v[132:133], v[204:205]
v_pk_mul_f32 v[134:135], v[134:135], v[206:207]
v_pk_mul_f32 v[136:137], v[136:137], v[208:209]
v_pk_mul_f32 v[138:139], v[138:139], v[210:211]
v_cvt_pk_bf16_f32 v204, v132, v133
v_cvt_pk_bf16_f32 v205, v134, v135
v_cvt_pk_bf16_f32 v206, v136, v137
v_cvt_pk_bf16_f32 v207, v138, v139
buffer_store_dwordx4 v[204:207], v10, s[12:15], s79 offen offset:512 sc1
v_pk_fma_f32 v[132:133], v[228:229], v[150:151], v[236:237]
v_pk_fma_f32 v[134:135], v[230:231], v[150:151], v[238:239]
v_pk_fma_f32 v[136:137], v[232:233], v[150:151], v[240:241]
v_pk_fma_f32 v[138:139], v[234:235], v[150:151], v[242:243]
v_pk_fma_f32 v[220:221], v[220:221], v[148:149], v[132:133]
v_pk_fma_f32 v[222:223], v[222:223], v[148:149], v[134:135]
v_pk_fma_f32 v[224:225], v[224:225], v[148:149], v[136:137]
v_pk_fma_f32 v[226:227], v[226:227], v[148:149], v[138:139]
v_pk_mul_f32 v[132:133], v[220:221], v[220:221]
v_pk_mul_f32 v[134:135], v[222:223], v[222:223]
v_pk_mul_f32 v[136:137], v[224:225], v[224:225]
v_pk_mul_f32 v[138:139], v[226:227], v[226:227]
v_pk_fma_f32 v[132:133], v[132:133], s[20:21], v[152:153]
v_pk_fma_f32 v[134:135], v[134:135], s[20:21], v[152:153]
v_pk_fma_f32 v[136:137], v[136:137], s[20:21], v[152:153]
v_pk_fma_f32 v[138:139], v[138:139], s[20:21], v[152:153]
v_pk_mul_f32 v[132:133], v[132:133], v[220:221]
v_pk_mul_f32 v[134:135], v[134:135], v[222:223]
v_pk_mul_f32 v[136:137], v[136:137], v[224:225]
v_pk_mul_f32 v[138:139], v[138:139], v[226:227]
v_exp_f32 v132, v132
v_exp_f32 v133, v133
v_exp_f32 v134, v134
v_exp_f32 v135, v135
v_exp_f32 v136, v136
v_exp_f32 v137, v137
v_exp_f32 v138, v138
v_exp_f32 v139, v139
v_pk_add_f32 v[132:133], v[132:133], s[22:23]
v_pk_add_f32 v[134:135], v[134:135], s[22:23]
v_pk_add_f32 v[136:137], v[136:137], s[22:23]
v_pk_add_f32 v[138:139], v[138:139], s[22:23]
v_rcp_f32 v132, v132
v_rcp_f32 v133, v133
v_rcp_f32 v134, v134
v_rcp_f32 v135, v135
v_rcp_f32 v136, v136
v_rcp_f32 v137, v137
v_rcp_f32 v138, v138
v_rcp_f32 v139, v139
v_pk_mul_f32 v[132:133], v[132:133], v[220:221]
v_pk_mul_f32 v[134:135], v[134:135], v[222:223]
v_pk_mul_f32 v[136:137], v[136:137], v[224:225]
v_pk_mul_f32 v[138:139], v[138:139], v[226:227]
v_cvt_pk_bf16_f32 v220, v132, v133
v_cvt_pk_bf16_f32 v221, v134, v135
v_cvt_pk_bf16_f32 v222, v136, v137
v_cvt_pk_bf16_f32 v223, v138, v139
buffer_store_dwordx4 v[220:223], v10, s[12:15], s79 offen offset:2560 sc1
s_barrier
v_mov_b32 v140, 0
v_mov_b32 v141, s96
buffer_load_dwordx4 v[184:187], v12, s[16:19], s61 offen
buffer_load_dwordx4 v[188:191], v12, s[16:19], s61 offen offset:16
buffer_load_dwordx2 v[192:193], v12, s[16:19], s61 offen offset:32
buffer_load_dwordx4 v[244:247], v15, s[4:7], s100 offen
buffer_load_dwordx4 v[248:251], v15, s[4:7], s100 offen offset:16
buffer_load_dwordx2 v[252:253], v15, s[4:7], s100 offen offset:32
s_lshl_b32 s84, s3, 2
s_add_u32 s84, s84, 163728
v_mov_b32 v2, s84
s_xor_b32 s84, s3, 0
s_lshl_b32 s84, s84, 10
v_add_u32 v4, s84, v1
s_xor_b32 s84, s3, 1
s_lshl_b32 s84, s84, 10
v_add_u32 v5, s84, v1
s_xor_b32 s84, s3, 2
s_lshl_b32 s84, s84, 10
v_add_u32 v6, s84, v1
s_xor_b32 s84, s3, 3
s_lshl_b32 s84, s84, 10
v_add_u32 v7, s84, v1
s_mul_i32 s84, s3, 5120
v_add_u32 v8, s84, v1
s_lshr_b32 s84, s3, 1
s_mul_i32 s84, s84, 21216
s_and_b32 s85, s3, 1
s_mul_i32 s85, s85, 10240
s_add_u32 s84, s84, s85
s_add_u32 s84, s84, 61440
v_add_u32 v9, s84, v1
s_waitcnt vmcnt(6)
buffer_store_dword v141, v140, s[12:15], s82 offen sc1
s_lshl2_add_u32 s84, s70, s3
s_mul_i32 s84, s84, 4352
s_add_u32 s84, s84, 13553664
v_min_u32 v10, 5, v0
v_lshlrev_b32 v10, 2, v10
s_mov_b32 s97, 0
MG0_hp_loop:
buffer_load_dword v11, v10, s[12:15], s84 offen sc1
s_add_u32 s97, s97, 1
s_waitcnt vmcnt(0)
v_cmp_ne_u32 vcc, s96, v11
s_cmp_ge_u32 s97, 32768
s_cbranch_scc1 MG0_hp_done
s_cbranch_vccnz MG0_hp_loop
MG0_hp_done:
G2:
s_lshl_b32 s80, s92, 12
s_add_u32 s80, s80, s98
s_add_u32 s88, s98, 49152
buffer_load_dwordx4 v[116:119], v4, s[12:15], s80 offen
buffer_load_dwordx4 v[120:123], v5, s[12:15], s80 offen
buffer_load_dwordx4 v[124:127], v6, s[12:15], s80 offen
buffer_load_dwordx4 v[128:131], v7, s[12:15], s80 offen
s_add_u32 s80, s80, 4096
s_cmp_eq_u32 s80, s88
s_cselect_b32 s80, s98, s80
buffer_load_dwordx4 v[132:135], v4, s[12:15], s80 offen
buffer_load_dwordx4 v[136:139], v5, s[12:15], s80 offen
buffer_load_dwordx4 v[140:143], v6, s[12:15], s80 offen
buffer_load_dwordx4 v[144:147], v7, s[12:15], s80 offen
s_add_u32 s80, s80, 4096
s_cmp_eq_u32 s80, s88
s_cselect_b32 s80, s98, s80
buffer_load_dwordx4 v[148:151], v4, s[12:15], s80 offen
buffer_load_dwordx4 v[152:155], v5, s[12:15], s80 offen
buffer_load_dwordx4 v[156:159], v6, s[12:15], s80 offen
buffer_load_dwordx4 v[160:163], v7, s[12:15], s80 offen
buffer_load_dword v254, v13, s[12:15], s101 offen offset:8 sc1
v_lshlrev_b32 v164, 16, v184
v_and_b32 v165, 0xffff0000, v184
v_lshlrev_b32 v166, 16, v185
v_and_b32 v167, 0xffff0000, v185
v_lshlrev_b32 v168, 16, v186
v_and_b32 v169, 0xffff0000, v186
v_lshlrev_b32 v170, 16, v187
v_and_b32 v171, 0xffff0000, v187
v_lshlrev_b32 v172, 16, v188
v_and_b32 v173, 0xffff0000, v188
v_lshlrev_b32 v174, 16, v189
v_and_b32 v175, 0xffff0000, v189
v_lshlrev_b32 v176, 16, v190
v_and_b32 v177, 0xffff0000, v190
v_lshlrev_b32 v178, 16, v191
v_and_b32 v179, 0xffff0000, v191
v_lshlrev_b32 v180, 16, v192
v_and_b32 v181, 0xffff0000, v192
v_lshlrev_b32 v182, 16, v193
v_and_b32 v183, 0xffff0000, v193
s_xor_b32 s84, s3, 1
s_mul_i32 s84, s84, 5120
s_add_u32 s84, s84, 0
v_add_u32 v10, s84, v1
s_xor_b32 s84, s3, 2
s_mul_i32 s84, s84, 5120
s_add_u32 s84, s84, 20480
v_add_u32 v11, s84, v1
s_xor_b32 s84, s3, 3
s_mul_i32 s84, s84, 5120
s_add_u32 s84, s84, 40960
v_add_u32 v12, s84, v1
v_bfe_u32 v14, v0, 3, 2
v_xor_b32 v14, s3, v14
v_lshlrev_b32 v14, 5, v14
v_lshrrev_b32 v13, 4, v0
v_lshl_add_u32 v13, v13, 12, v14
v_bfe_u32 v14, v0, 2, 2
v_lshl_add_u32 v13, v14, 7, v13
v_and_b32 v14, 3, v0
v_lshl_add_u32 v13, v14, 3, v13
v_add_u32 v13, 146304, v13
s_waitcnt vmcnt(9)
v_mfma_f32_16x16x32_bf16 v[164:167], v[16:19], v[116:119], v[164:167]
v_mfma_f32_16x16x32_bf16 v[168:171], v[20:23], v[116:119], v[168:171]
v_mfma_f32_16x16x32_bf16 v[172:175], v[24:27], v[116:119], v[172:175]
v_mfma_f32_16x16x32_bf16 v[176:179], v[28:31], v[116:119], v[176:179]
v_mfma_f32_16x16x32_bf16 v[180:183], v[32:35], v[116:119], v[180:183]
v_mfma_f32_16x16x32_bf16 v[184:187], v[16:19], v[120:123], 0
v_mfma_f32_16x16x32_bf16 v[188:191], v[20:23], v[120:123], 0
v_mfma_f32_16x16x32_bf16 v[192:195], v[24:27], v[120:123], 0
v_mfma_f32_16x16x32_bf16 v[196:199], v[28:31], v[120:123], 0
v_mfma_f32_16x16x32_bf16 v[200:203], v[32:35], v[120:123], 0
v_mfma_f32_16x16x32_bf16 v[204:207], v[16:19], v[124:127], 0
v_mfma_f32_16x16x32_bf16 v[208:211], v[20:23], v[124:127], 0
v_mfma_f32_16x16x32_bf16 v[212:215], v[24:27], v[124:127], 0
v_mfma_f32_16x16x32_bf16 v[216:219], v[28:31], v[124:127], 0
v_mfma_f32_16x16x32_bf16 v[220:223], v[32:35], v[124:127], 0
v_mfma_f32_16x16x32_bf16 v[224:227], v[16:19], v[128:131], 0
v_mfma_f32_16x16x32_bf16 v[228:231], v[20:23], v[128:131], 0
v_mfma_f32_16x16x32_bf16 v[232:235], v[24:27], v[128:131], 0
v_mfma_f32_16x16x32_bf16 v[236:239], v[28:31], v[128:131], 0
v_mfma_f32_16x16x32_bf16 v[240:243], v[32:35], v[128:131], 0
s_add_u32 s80, s80, 4096
s_cmp_eq_u32 s80, s88
s_cselect_b32 s80, s98, s80
buffer_load_dwordx4 v[116:119], v4, s[12:15], s80 offen
buffer_load_dwordx4 v[120:123], v5, s[12:15], s80 offen
buffer_load_dwordx4 v[124:127], v6, s[12:15], s80 offen
buffer_load_dwordx4 v[128:131], v7, s[12:15], s80 offen
s_cmp_ge_u32 s92, 2
s_cselect_b32 s81, s60, s99
s_add_u32 s81, s81, 51200
buffer_load_dwordx4 v[16:19], v1, s[12:15], s81 offen offset:0
buffer_load_dwordx4 v[20:23], v1, s[12:15], s81 offen offset:1024
buffer_load_dwordx4 v[24:27], v1, s[12:15], s81 offen offset:2048
buffer_load_dwordx4 v[28:31], v1, s[12:15], s81 offen offset:3072
buffer_load_dwordx4 v[32:35], v3, s[12:15], s81 offen offset:0
s_waitcnt vmcnt(14)
v_mfma_f32_16x16x32_bf16 v[164:167], v[36:39], v[132:135], v[164:167]
v_mfma_f32_16x16x32_bf16 v[168:171], v[40:43], v[132:135], v[168:171]
v_mfma_f32_16x16x32_bf16 v[172:175], v[44:47], v[132:135], v[172:175]
v_mfma_f32_16x16x32_bf16 v[176:179], v[48:51], v[132:135], v[176:179]
v_mfma_f32_16x16x32_bf16 v[180:183], v[52:55], v[132:135], v[180:183]
v_mfma_f32_16x16x32_bf16 v[184:187], v[36:39], v[136:139], v[184:187]
v_mfma_f32_16x16x32_bf16 v[188:191], v[40:43], v[136:139], v[188:191]
v_mfma_f32_16x16x32_bf16 v[192:195], v[44:47], v[136:139], v[192:195]
v_mfma_f32_16x16x32_bf16 v[196:199], v[48:51], v[136:139], v[196:199]
v_mfma_f32_16x16x32_bf16 v[200:203], v[52:55], v[136:139], v[200:203]
v_mfma_f32_16x16x32_bf16 v[204:207], v[36:39], v[140:143], v[204:207]
v_mfma_f32_16x16x32_bf16 v[208:211], v[40:43], v[140:143], v[208:211]
v_mfma_f32_16x16x32_bf16 v[212:215], v[44:47], v[140:143], v[212:215]
v_mfma_f32_16x16x32_bf16 v[216:219], v[48:51], v[140:143], v[216:219]
v_mfma_f32_16x16x32_bf16 v[220:223], v[52:55], v[140:143], v[220:223]
v_mfma_f32_16x16x32_bf16 v[224:227], v[36:39], v[144:147], v[224:227]
v_mfma_f32_16x16x32_bf16 v[228:231], v[40:43], v[144:147], v[228:231]
v_mfma_f32_16x16x32_bf16 v[232:235], v[44:47], v[144:147], v[232:235]
v_mfma_f32_16x16x32_bf16 v[236:239], v[48:51], v[144:147], v[236:239]
v_mfma_f32_16x16x32_bf16 v[240:243], v[52:55], v[144:147], v[240:243]
s_add_u32 s80, s80, 4096
s_cmp_eq_u32 s80, s88
s_cselect_b32 s80, s98, s80
buffer_load_dwordx4 v[132:135], v4, s[12:15], s80 offen
buffer_load_dwordx4 v[136:139], v5, s[12:15], s80 offen
buffer_load_dwordx4 v[140:143], v6, s[12:15], s80 offen
buffer_load_dwordx4 v[144:147], v7, s[12:15], s80 offen
s_cmp_ge_u32 s92, 1
s_cselect_b32 s81, s60, s99
s_add_u32 s81, s81, 56320
buffer_load_dwordx4 v[36:39], v1, s[12:15], s81 offen offset:0
buffer_load_dwordx4 v[40:43], v1, s[12:15], s81 offen offset:1024
buffer_load_dwordx4 v[44:47], v1, s[12:15], s81 offen offset:2048
buffer_load_dwordx4 v[48:51], v1, s[12:15], s81 offen offset:3072
buffer_load_dwordx4 v[52:55], v3, s[12:15], s81 offen offset:0
s_waitcnt vmcnt(19)
v_mfma_f32_16x16x32_bf16 v[164:167], v[56:59], v[148:151], v[164:167]
v_mfma_f32_16x16x32_bf16 v[168:171], v[60:63], v[148:151], v[168:171]
v_mfma_f32_16x16x32_bf16 v[172:175], v[64:67], v[148:151], v[172:175]
v_mfma_f32_16x16x32_bf16 v[176:179], v[68:71], v[148:151], v[176:179]
v_mfma_f32_16x16x32_bf16 v[180:183], v[72:75], v[148:151], v[180:183]
v_mfma_f32_16x16x32_bf16 v[184:187], v[56:59], v[152:155], v[184:187]
v_mfma_f32_16x16x32_bf16 v[188:191], v[60:63], v[152:155], v[188:191]
v_mfma_f32_16x16x32_bf16 v[192:195], v[64:67], v[152:155], v[192:195]
v_mfma_f32_16x16x32_bf16 v[196:199], v[68:71], v[152:155], v[196:199]
v_mfma_f32_16x16x32_bf16 v[200:203], v[72:75], v[152:155], v[200:203]
v_mfma_f32_16x16x32_bf16 v[204:207], v[56:59], v[156:159], v[204:207]
v_mfma_f32_16x16x32_bf16 v[208:211], v[60:63], v[156:159], v[208:211]
v_mfma_f32_16x16x32_bf16 v[212:215], v[64:67], v[156:159], v[212:215]
v_mfma_f32_16x16x32_bf16 v[216:219], v[68:71], v[156:159], v[216:219]
v_mfma_f32_16x16x32_bf16 v[220:223], v[72:75], v[156:159], v[220:223]
v_mfma_f32_16x16x32_bf16 v[224:227], v[56:59], v[160:163], v[224:227]
ds_read_b32 v14, v2
v_mfma_f32_16x16x32_bf16 v[228:231], v[60:63], v[160:163], v[228:231]
v_mfma_f32_16x16x32_bf16 v[232:235], v[64:67], v[160:163], v[232:235]
v_mfma_f32_16x16x32_bf16 v[236:239], v[68:71], v[160:163], v[236:239]
v_mfma_f32_16x16x32_bf16 v[240:243], v[72:75], v[160:163], v[240:243]
s_add_u32 s80, s80, 4096
s_cmp_eq_u32 s80, s88
s_cselect_b32 s80, s98, s80
buffer_load_dwordx4 v[148:151], v4, s[12:15], s80 offen
buffer_load_dwordx4 v[152:155], v5, s[12:15], s80 offen
buffer_load_dwordx4 v[156:159], v6, s[12:15], s80 offen
buffer_load_dwordx4 v[160:163], v7, s[12:15], s80 offen
s_waitcnt vmcnt(18)
s_waitcnt lgkmcnt(0)
v_cmp_gt_u32 vcc, 1, v14
s_nop 1
s_cbranch_vccz G2_ls_done
s_mov_b32 s97, 0
G2_ls:
ds_read_b32 v14, v2
s_add_u32 s97, s97, 1
s_waitcnt lgkmcnt(0)
v_cmp_gt_u32 vcc, 1, v14
s_cmp_ge_u32 s97, 2097152
s_cbranch_scc1 G2_ls_done
s_cbranch_vccnz G2_ls
G2_ls_done:
v_mfma_f32_16x16x32_bf16 v[164:167], v[76:79], v[116:119], v[164:167]
ds_read_b128 v[56:59], v8 offset:0
v_mfma_f32_16x16x32_bf16 v[168:171], v[80:83], v[116:119], v[168:171]
v_mfma_f32_16x16x32_bf16 v[172:175], v[84:87], v[116:119], v[172:175]
v_mfma_f32_16x16x32_bf16 v[176:179], v[88:91], v[116:119], v[176:179]
v_mfma_f32_16x16x32_bf16 v[180:183], v[92:95], v[116:119], v[180:183]
ds_read_b128 v[60:63], v8 offset:1024
v_mfma_f32_16x16x32_bf16 v[184:187], v[76:79], v[120:123], v[184:187]
v_mfma_f32_16x16x32_bf16 v[188:191], v[80:83], v[120:123], v[188:191]
v_mfma_f32_16x16x32_bf16 v[192:195], v[84:87], v[120:123], v[192:195]
v_mfma_f32_16x16x32_bf16 v[196:199], v[88:91], v[120:123], v[196:199]
ds_read_b128 v[64:67], v8 offset:2048
v_mfma_f32_16x16x32_bf16 v[200:203], v[92:95], v[120:123], v[200:203]
v_mfma_f32_16x16x32_bf16 v[204:207], v[76:79], v[124:127], v[204:207]
v_mfma_f32_16x16x32_bf16 v[208:211], v[80:83], v[124:127], v[208:211]
v_mfma_f32_16x16x32_bf16 v[212:215], v[84:87], v[124:127], v[212:215]
ds_read_b128 v[68:71], v8 offset:3072
v_mfma_f32_16x16x32_bf16 v[216:219], v[88:91], v[124:127], v[216:219]
v_mfma_f32_16x16x32_bf16 v[220:223], v[92:95], v[124:127], v[220:223]
v_mfma_f32_16x16x32_bf16 v[224:227], v[76:79], v[128:131], v[224:227]
v_mfma_f32_16x16x32_bf16 v[228:231], v[80:83], v[128:131], v[228:231]
ds_read_b128 v[72:75], v8 offset:4096
v_mfma_f32_16x16x32_bf16 v[232:235], v[84:87], v[128:131], v[232:235]
v_mfma_f32_16x16x32_bf16 v[236:239], v[88:91], v[128:131], v[236:239]
v_mfma_f32_16x16x32_bf16 v[240:243], v[92:95], v[128:131], v[240:243]
s_add_u32 s80, s80, 4096
s_cmp_eq_u32 s80, s88
s_cselect_b32 s80, s98, s80
buffer_load_dwordx4 v[116:119], v4, s[12:15], s80 offen
buffer_load_dwordx4 v[120:123], v5, s[12:15], s80 offen
buffer_load_dwordx4 v[124:127], v6, s[12:15], s80 offen
buffer_load_dwordx4 v[128:131], v7, s[12:15], s80 offen
s_waitcnt vmcnt(13)
v_mfma_f32_16x16x32_bf16 v[164:167], v[96:99], v[132:135], v[164:167]
ds_read_b128 v[76:79], v8 offset:20480
v_mfma_f32_16x16x32_bf16 v[168:171], v[100:103], v[132:135], v[168:171]
v_mfma_f32_16x16x32_bf16 v[172:175], v[104:107], v[132:135], v[172:175]
v_mfma_f32_16x16x32_bf16 v[176:179], v[108:111], v[132:135], v[176:179]
v_mfma_f32_16x16x32_bf16 v[180:183], v[112:115], v[132:135], v[180:183]
ds_read_b128 v[80:83], v8 offset:21504
v_mfma_f32_16x16x32_bf16 v[184:187], v[96:99], v[136:139], v[184:187]
v_mfma_f32_16x16x32_bf16 v[188:191], v[100:103], v[136:139], v[188:191]
v_mfma_f32_16x16x32_bf16 v[192:195], v[104:107], v[136:139], v[192:195]
v_mfma_f32_16x16x32_bf16 v[196:199], v[108:111], v[136:139], v[196:199]
ds_read_b128 v[84:87], v8 offset:22528
v_mfma_f32_16x16x32_bf16 v[200:203], v[112:115], v[136:139], v[200:203]
v_mfma_f32_16x16x32_bf16 v[204:207], v[96:99], v[140:143], v[204:207]
v_mfma_f32_16x16x32_bf16 v[208:211], v[100:103], v[140:143], v[208:211]
v_mfma_f32_16x16x32_bf16 v[212:215], v[104:107], v[140:143], v[212:215]
ds_read_b128 v[88:91], v8 offset:23552
v_mfma_f32_16x16x32_bf16 v[216:219], v[108:111], v[140:143], v[216:219]
v_mfma_f32_16x16x32_bf16 v[220:223], v[112:115], v[140:143], v[220:223]
v_mfma_f32_16x16x32_bf16 v[224:227], v[96:99], v[144:147], v[224:227]
v_mfma_f32_16x16x32_bf16 v[228:231], v[100:103], v[144:147], v[228:231]
ds_read_b128 v[92:95], v8 offset:24576
v_mfma_f32_16x16x32_bf16 v[232:235], v[104:107], v[144:147], v[232:235]
v_mfma_f32_16x16x32_bf16 v[236:239], v[108:111], v[144:147], v[236:239]
v_mfma_f32_16x16x32_bf16 v[240:243], v[112:115], v[144:147], v[240:243]
s_add_u32 s80, s80, 4096
s_cmp_eq_u32 s80, s88
s_cselect_b32 s80, s98, s80
buffer_load_dwordx4 v[132:135], v4, s[12:15], s80 offen
buffer_load_dwordx4 v[136:139], v5, s[12:15], s80 offen
buffer_load_dwordx4 v[140:143], v6, s[12:15], s80 offen
buffer_load_dwordx4 v[144:147], v7, s[12:15], s80 offen
s_waitcnt vmcnt(8)
s_waitcnt lgkmcnt(5)
v_mfma_f32_16x16x32_bf16 v[164:167], v[56:59], v[148:151], v[164:167]
ds_read_b128 v[96:99], v8 offset:40960
v_mfma_f32_16x16x32_bf16 v[168:171], v[60:63], v[148:151], v[168:171]
v_mfma_f32_16x16x32_bf16 v[172:175], v[64:67], v[148:151], v[172:175]
v_mfma_f32_16x16x32_bf16 v[176:179], v[68:71], v[148:151], v[176:179]
v_mfma_f32_16x16x32_bf16 v[180:183], v[72:75], v[148:151], v[180:183]
ds_read_b128 v[100:103], v8 offset:41984
v_mfma_f32_16x16x32_bf16 v[184:187], v[56:59], v[152:155], v[184:187]
v_mfma_f32_16x16x32_bf16 v[188:191], v[60:63], v[152:155], v[188:191]
v_mfma_f32_16x16x32_bf16 v[192:195], v[64:67], v[152:155], v[192:195]
v_mfma_f32_16x16x32_bf16 v[196:199], v[68:71], v[152:155], v[196:199]
ds_read_b128 v[104:107], v8 offset:43008
v_mfma_f32_16x16x32_bf16 v[200:203], v[72:75], v[152:155], v[200:203]
v_mfma_f32_16x16x32_bf16 v[204:207], v[56:59], v[156:159], v[204:207]
v_mfma_f32_16x16x32_bf16 v[208:211], v[60:63], v[156:159], v[208:211]
v_mfma_f32_16x16x32_bf16 v[212:215], v[64:67], v[156:159], v[212:215]
ds_read_b128 v[108:111], v8 offset:44032
v_mfma_f32_16x16x32_bf16 v[216:219], v[68:71], v[156:159], v[216:219]
v_mfma_f32_16x16x32_bf16 v[220:223], v[72:75], v[156:159], v[220:223]
v_mfma_f32_16x16x32_bf16 v[224:227], v[56:59], v[160:163], v[224:227]
v_mfma_f32_16x16x32_bf16 v[228:231], v[60:63], v[160:163], v[228:231]
ds_read_b128 v[112:115], v8 offset:45056
v_mfma_f32_16x16x32_bf16 v[232:235], v[64:67], v[160:163], v[232:235]
v_mfma_f32_16x16x32_bf16 v[236:239], v[68:71], v[160:163], v[236:239]
v_mfma_f32_16x16x32_bf16 v[240:243], v[72:75], v[160:163], v[240:243]
s_add_u32 s80, s80, 4096
s_cmp_eq_u32 s80, s88
s_cselect_b32 s80, s98, s80
buffer_load_dwordx4 v[148:151], v4, s[12:15], s80 offen
buffer_load_dwordx4 v[152:155], v5, s[12:15], s80 offen
buffer_load_dwordx4 v[156:159], v6, s[12:15], s80 offen
buffer_load_dwordx4 v[160:163], v7, s[12:15], s80 offen
s_waitcnt vmcnt(8)
s_waitcnt lgkmcnt(5)
v_mfma_f32_16x16x32_bf16 v[164:167], v[76:79], v[116:119], v[164:167]
ds_read_b128 v[56:59], v9 offset:0
v_mfma_f32_16x16x32_bf16 v[168:171], v[80:83], v[116:119], v[168:171]
v_mfma_f32_16x16x32_bf16 v[172:175], v[84:87], v[116:119], v[172:175]
v_mfma_f32_16x16x32_bf16 v[176:179], v[88:91], v[116:119], v[176:179]
v_mfma_f32_16x16x32_bf16 v[180:183], v[92:95], v[116:119], v[180:183]
ds_read_b128 v[60:63], v9 offset:1024
v_mfma_f32_16x16x32_bf16 v[184:187], v[76:79], v[120:123], v[184:187]
v_mfma_f32_16x16x32_bf16 v[188:191], v[80:83], v[120:123], v[188:191]
v_mfma_f32_16x16x32_bf16 v[192:195], v[84:87], v[120:123], v[192:195]
v_mfma_f32_16x16x32_bf16 v[196:199], v[88:91], v[120:123], v[196:199]
ds_read_b128 v[64:67], v9 offset:2048
v_mfma_f32_16x16x32_bf16 v[200:203], v[92:95], v[120:123], v[200:203]
v_mfma_f32_16x16x32_bf16 v[204:207], v[76:79], v[124:127], v[204:207]
v_mfma_f32_16x16x32_bf16 v[208:211], v[80:83], v[124:127], v[208:211]
v_mfma_f32_16x16x32_bf16 v[212:215], v[84:87], v[124:127], v[212:215]
ds_read_b128 v[68:71], v9 offset:3072
v_mfma_f32_16x16x32_bf16 v[216:219], v[88:91], v[124:127], v[216:219]
v_mfma_f32_16x16x32_bf16 v[220:223], v[92:95], v[124:127], v[220:223]
v_mfma_f32_16x16x32_bf16 v[224:227], v[76:79], v[128:131], v[224:227]
v_mfma_f32_16x16x32_bf16 v[228:231], v[80:83], v[128:131], v[228:231]
ds_read_b128 v[72:75], v9 offset:4096
v_mfma_f32_16x16x32_bf16 v[232:235], v[84:87], v[128:131], v[232:235]
v_mfma_f32_16x16x32_bf16 v[236:239], v[88:91], v[128:131], v[236:239]
v_mfma_f32_16x16x32_bf16 v[240:243], v[92:95], v[128:131], v[240:243]
s_add_u32 s80, s80, 4096
s_cmp_eq_u32 s80, s88
s_cselect_b32 s80, s98, s80
buffer_load_dwordx4 v[116:119], v4, s[12:15], s80 offen
buffer_load_dwordx4 v[120:123], v5, s[12:15], s80 offen
buffer_load_dwordx4 v[124:127], v6, s[12:15], s80 offen
buffer_load_dwordx4 v[128:131], v7, s[12:15], s80 offen
s_waitcnt vmcnt(8)
s_waitcnt lgkmcnt(5)
v_mfma_f32_16x16x32_bf16 v[164:167], v[96:99], v[132:135], v[164:167]
ds_read_b128 v[76:79], v9 offset:5120
v_mfma_f32_16x16x32_bf16 v[168:171], v[100:103], v[132:135], v[168:171]
v_mfma_f32_16x16x32_bf16 v[172:175], v[104:107], v[132:135], v[172:175]
v_mfma_f32_16x16x32_bf16 v[176:179], v[108:111], v[132:135], v[176:179]
v_mfma_f32_16x16x32_bf16 v[180:183], v[112:115], v[132:135], v[180:183]
ds_read_b128 v[80:83], v9 offset:6144
v_mfma_f32_16x16x32_bf16 v[184:187], v[96:99], v[136:139], v[184:187]
v_mfma_f32_16x16x32_bf16 v[188:191], v[100:103], v[136:139], v[188:191]
v_mfma_f32_16x16x32_bf16 v[192:195], v[104:107], v[136:139], v[192:195]
v_mfma_f32_16x16x32_bf16 v[196:199], v[108:111], v[136:139], v[196:199]
ds_read_b128 v[84:87], v9 offset:7168
v_mfma_f32_16x16x32_bf16 v[200:203], v[112:115], v[136:139], v[200:203]
v_mfma_f32_16x16x32_bf16 v[204:207], v[96:99], v[140:143], v[204:207]
v_mfma_f32_16x16x32_bf16 v[208:211], v[100:103], v[140:143], v[208:211]
v_mfma_f32_16x16x32_bf16 v[212:215], v[104:107], v[140:143], v[212:215]
ds_read_b128 v[88:91], v9 offset:8192
v_mfma_f32_16x16x32_bf16 v[216:219], v[108:111], v[140:143], v[216:219]
v_mfma_f32_16x16x32_bf16 v[220:223], v[112:115], v[140:143], v[220:223]
v_mfma_f32_16x16x32_bf16 v[224:227], v[96:99], v[144:147], v[224:227]
v_mfma_f32_16x16x32_bf16 v[228:231], v[100:103], v[144:147], v[228:231]
ds_read_b128 v[92:95], v9 offset:9216
v_mfma_f32_16x16x32_bf16 v[232:235], v[104:107], v[144:147], v[232:235]
v_mfma_f32_16x16x32_bf16 v[236:239], v[108:111], v[144:147], v[236:239]
v_mfma_f32_16x16x32_bf16 v[240:243], v[112:115], v[144:147], v[240:243]
s_add_u32 s80, s80, 4096
s_cmp_eq_u32 s80, s88
s_cselect_b32 s80, s98, s80
buffer_load_dwordx4 v[132:135], v4, s[12:15], s80 offen
buffer_load_dwordx4 v[136:139], v5, s[12:15], s80 offen
buffer_load_dwordx4 v[140:143], v6, s[12:15], s80 offen
buffer_load_dwordx4 v[144:147], v7, s[12:15], s80 offen
s_waitcnt vmcnt(8)
s_waitcnt lgkmcnt(5)
v_mfma_f32_16x16x32_bf16 v[164:167], v[56:59], v[148:151], v[164:167]
v_lshlrev_b32 v96, 16, v244
v_and_b32 v97, 0xffff0000, v244
v_mfma_f32_16x16x32_bf16 v[168:171], v[60:63], v[148:151], v[168:171]
v_mfma_f32_16x16x32_bf16 v[172:175], v[64:67], v[148:151], v[172:175]
v_lshlrev_b32 v98, 16, v245
v_and_b32 v99, 0xffff0000, v245
v_mfma_f32_16x16x32_bf16 v[176:179], v[68:71], v[148:151], v[176:179]
v_mfma_f32_16x16x32_bf16 v[180:183], v[72:75], v[148:151], v[180:183]
v_lshlrev_b32 v100, 16, v246
v_and_b32 v101, 0xffff0000, v246
v_mfma_f32_16x16x32_bf16 v[184:187], v[56:59], v[152:155], v[184:187]
v_mfma_f32_16x16x32_bf16 v[188:191], v[60:63], v[152:155], v[188:191]
v_lshlrev_b32 v102, 16, v247
v_and_b32 v103, 0xffff0000, v247
v_mfma_f32_16x16x32_bf16 v[192:195], v[64:67], v[152:155], v[192:195]
v_mfma_f32_16x16x32_bf16 v[196:199], v[68:71], v[152:155], v[196:199]
v_lshlrev_b32 v104, 16, v248
v_and_b32 v105, 0xffff0000, v248
v_mfma_f32_16x16x32_bf16 v[200:203], v[72:75], v[152:155], v[200:203]
v_mfma_f32_16x16x32_bf16 v[204:207], v[56:59], v[156:159], v[204:207]
v_lshlrev_b32 v106, 16, v249
v_and_b32 v107, 0xffff0000, v249
v_mfma_f32_16x16x32_bf16 v[208:211], v[60:63], v[156:159], v[208:211]
v_mfma_f32_16x16x32_bf16 v[212:215], v[64:67], v[156:159], v[212:215]
v_lshlrev_b32 v108, 16, v250
v_and_b32 v109, 0xffff0000, v250
v_mfma_f32_16x16x32_bf16 v[216:219], v[68:71], v[156:159], v[216:219]
v_mfma_f32_16x16x32_bf16 v[220:223], v[72:75], v[156:159], v[220:223]
v_lshlrev_b32 v110, 16, v251
v_and_b32 v111, 0xffff0000, v251
v_mfma_f32_16x16x32_bf16 v[224:227], v[56:59], v[160:163], v[224:227]
v_mfma_f32_16x16x32_bf16 v[228:231], v[60:63], v[160:163], v[228:231]
v_lshlrev_b32 v112, 16, v252
v_and_b32 v113, 0xffff0000, v252
v_mfma_f32_16x16x32_bf16 v[232:235], v[64:67], v[160:163], v[232:235]
v_mfma_f32_16x16x32_bf16 v[236:239], v[68:71], v[160:163], v[236:239]
v_lshlrev_b32 v114, 16, v253
v_and_b32 v115, 0xffff0000, v253
v_mfma_f32_16x16x32_bf16 v[240:243], v[72:75], v[160:163], v[240:243]
s_add_u32 s80, s80, 4096
s_cmp_eq_u32 s80, s88
s_cselect_b32 s80, s98, s80
buffer_load_dwordx4 v[148:151], v4, s[12:15], s80 offen
buffer_load_dwordx4 v[152:155], v5, s[12:15], s80 offen
buffer_load_dwordx4 v[156:159], v6, s[12:15], s80 offen
buffer_load_dwordx4 v[160:163], v7, s[12:15], s80 offen
ds_write_b32 v2, v2 offset:16
s_waitcnt vmcnt(8)
s_waitcnt lgkmcnt(1)
v_mfma_f32_16x16x32_bf16 v[164:167], v[76:79], v[116:119], v[164:167]
v_mul_f32 v96, v96, v254
v_mul_f32 v97, v97, v254
v_mfma_f32_16x16x32_bf16 v[168:171], v[80:83], v[116:119], v[168:171]
v_mul_f32 v98, v98, v254
v_mul_f32 v99, v99, v254
v_mfma_f32_16x16x32_bf16 v[172:175], v[84:87], v[116:119], v[172:175]
v_mfma_f32_16x16x32_bf16 v[176:179], v[88:91], v[116:119], v[176:179]
v_mul_f32 v100, v100, v254
v_mul_f32 v101, v101, v254
v_mfma_f32_16x16x32_bf16 v[180:183], v[92:95], v[116:119], v[180:183]
v_mfma_f32_16x16x32_bf16 v[184:187], v[76:79], v[120:123], v[184:187]
v_mul_f32 v102, v102, v254
v_mul_f32 v103, v103, v254
v_mfma_f32_16x16x32_bf16 v[188:191], v[80:83], v[120:123], v[188:191]
v_mfma_f32_16x16x32_bf16 v[192:195], v[84:87], v[120:123], v[192:195]
v_mul_f32 v104, v104, v254
v_mul_f32 v105, v105, v254
v_mfma_f32_16x16x32_bf16 v[196:199], v[88:91], v[120:123], v[196:199]
v_mfma_f32_16x16x32_bf16 v[200:203], v[92:95], v[120:123], v[200:203]
v_mul_f32 v106, v106, v254
v_mul_f32 v107, v107, v254
v_mfma_f32_16x16x32_bf16 v[204:207], v[76:79], v[124:127], v[204:207]
v_mul_f32 v108, v108, v254
v_mul_f32 v109, v109, v254
v_mfma_f32_16x16x32_bf16 v[208:211], v[80:83], v[124:127], v[208:211]
v_mfma_f32_16x16x32_bf16 v[212:215], v[84:87], v[124:127], v[212:215]
v_mul_f32 v110, v110, v254
v_mul_f32 v111, v111, v254
v_mfma_f32_16x16x32_bf16 v[216:219], v[88:91], v[124:127], v[216:219]
v_mfma_f32_16x16x32_bf16 v[220:223], v[92:95], v[124:127], v[220:223]
v_mul_f32 v112, v112, v254
v_mul_f32 v113, v113, v254
v_mfma_f32_16x16x32_bf16 v[224:227], v[76:79], v[128:131], v[224:227]
v_mfma_f32_16x16x32_bf16 v[228:231], v[80:83], v[128:131], v[228:231]
v_mul_f32 v114, v114, v254
v_mul_f32 v115, v115, v254
v_mfma_f32_16x16x32_bf16 v[232:235], v[84:87], v[128:131], v[232:235]
v_mfma_f32_16x16x32_bf16 v[236:239], v[88:91], v[128:131], v[236:239]
v_sub_f32 v2, 1.0, v254
v_sub_f32 v3, 1.0, v254
v_mfma_f32_16x16x32_bf16 v[240:243], v[92:95], v[128:131], v[240:243]
s_waitcnt vmcnt(4)
v_mfma_f32_16x16x32_bf16 v[164:167], v[16:19], v[132:135], v[164:167]
v_mfma_f32_16x16x32_bf16 v[168:171], v[20:23], v[132:135], v[168:171]
v_mfma_f32_16x16x32_bf16 v[172:175], v[24:27], v[132:135], v[172:175]
v_mfma_f32_16x16x32_bf16 v[176:179], v[28:31], v[132:135], v[176:179]
v_mfma_f32_16x16x32_bf16 v[180:183], v[32:35], v[132:135], v[180:183]
v_mfma_f32_16x16x32_bf16 v[184:187], v[16:19], v[136:139], v[184:187]
v_mfma_f32_16x16x32_bf16 v[188:191], v[20:23], v[136:139], v[188:191]
v_mfma_f32_16x16x32_bf16 v[192:195], v[24:27], v[136:139], v[192:195]
v_mfma_f32_16x16x32_bf16 v[196:199], v[28:31], v[136:139], v[196:199]
v_mfma_f32_16x16x32_bf16 v[200:203], v[32:35], v[136:139], v[200:203]
v_mfma_f32_16x16x32_bf16 v[204:207], v[16:19], v[140:143], v[204:207]
v_mfma_f32_16x16x32_bf16 v[208:211], v[20:23], v[140:143], v[208:211]
v_mfma_f32_16x16x32_bf16 v[212:215], v[24:27], v[140:143], v[212:215]
v_mfma_f32_16x16x32_bf16 v[216:219], v[28:31], v[140:143], v[216:219]
v_mfma_f32_16x16x32_bf16 v[220:223], v[32:35], v[140:143], v[220:223]
v_mfma_f32_16x16x32_bf16 v[224:227], v[16:19], v[144:147], v[224:227]
v_mfma_f32_16x16x32_bf16 v[228:231], v[20:23], v[144:147], v[228:231]
v_mfma_f32_16x16x32_bf16 v[232:235], v[24:27], v[144:147], v[232:235]
v_mfma_f32_16x16x32_bf16 v[236:239], v[28:31], v[144:147], v[236:239]
v_mfma_f32_16x16x32_bf16 v[240:243], v[32:35], v[144:147], v[240:243]
s_waitcnt vmcnt(0)
v_mfma_f32_16x16x32_bf16 v[184:187], v[36:39], v[152:155], v[184:187]
v_mfma_f32_16x16x32_bf16 v[188:191], v[40:43], v[152:155], v[188:191]
v_mfma_f32_16x16x32_bf16 v[192:195], v[44:47], v[152:155], v[192:195]
v_mfma_f32_16x16x32_bf16 v[196:199], v[48:51], v[152:155], v[196:199]
v_mfma_f32_16x16x32_bf16 v[200:203], v[52:55], v[152:155], v[200:203]
v_mfma_f32_16x16x32_bf16 v[204:207], v[36:39], v[156:159], v[204:207]
v_mfma_f32_16x16x32_bf16 v[208:211], v[40:43], v[156:159], v[208:211]
v_mfma_f32_16x16x32_bf16 v[212:215], v[44:47], v[156:159], v[212:215]
v_mfma_f32_16x16x32_bf16 v[216:219], v[48:51], v[156:159], v[216:219]
ds_write_b128 v8, v[184:187] offset:0
v_mfma_f32_16x16x32_bf16 v[220:223], v[52:55], v[156:159], v[220:223]
ds_write_b128 v8, v[188:191] offset:1024
v_mfma_f32_16x16x32_bf16 v[224:227], v[36:39], v[160:163], v[224:227]
ds_write_b128 v8, v[192:195] offset:2048
v_mfma_f32_16x16x32_bf16 v[228:231], v[40:43], v[160:163], v[228:231]
ds_write_b128 v8, v[196:199] offset:3072
v_mfma_f32_16x16x32_bf16 v[232:235], v[44:47], v[160:163], v[232:235]
ds_write_b128 v8, v[200:203] offset:4096
v_mfma_f32_16x16x32_bf16 v[236:239], v[48:51], v[160:163], v[236:239]
ds_write_b128 v8, v[204:207] offset:20480
v_mfma_f32_16x16x32_bf16 v[240:243], v[52:55], v[160:163], v[240:243]
ds_write_b128 v8, v[208:211] offset:21504
v_mfma_f32_16x16x32_bf16 v[164:167], v[36:39], v[148:151], v[164:167]
ds_write_b128 v8, v[212:215] offset:22528
v_mfma_f32_16x16x32_bf16 v[168:171], v[40:43], v[148:151], v[168:171]
ds_write_b128 v8, v[216:219] offset:23552
v_mfma_f32_16x16x32_bf16 v[172:175], v[44:47], v[148:151], v[172:175]
ds_write_b128 v8, v[220:223] offset:24576
v_mfma_f32_16x16x32_bf16 v[176:179], v[48:51], v[148:151], v[176:179]
v_mfma_f32_16x16x32_bf16 v[180:183], v[52:55], v[148:151], v[180:183]
ds_write_b128 v8, v[224:227] offset:40960
ds_write_b128 v8, v[228:231] offset:41984
ds_write_b128 v8, v[232:235] offset:43008
ds_write_b128 v8, v[236:239] offset:44032
ds_write_b128 v8, v[240:243] offset:45056
s_waitcnt lgkmcnt(0)
s_barrier
ds_read_b64_tr_b16 v[116:117], v13 offset:0
ds_read_b64_tr_b16 v[118:119], v13 offset:512
ds_read_b64_tr_b16 v[120:121], v13 offset:1024
ds_read_b64_tr_b16 v[122:123], v13 offset:1536
ds_read_b64_tr_b16 v[124:125], v13 offset:2048
ds_read_b128 v[184:187], v10 offset:0
ds_read_b128 v[188:191], v10 offset:1024
ds_read_b128 v[192:195], v10 offset:2048
ds_read_b128 v[196:199], v10 offset:3072
ds_read_b128 v[200:203], v10 offset:4096
ds_read_b128 v[204:207], v11 offset:0
ds_read_b128 v[208:211], v11 offset:1024
ds_read_b128 v[212:215], v11 offset:2048
ds_read_b128 v[216:219], v11 offset:3072
ds_read_b128 v[220:223], v11 offset:4096
ds_read_b128 v[224:227], v12 offset:0
ds_read_b128 v[228:231], v12 offset:1024
ds_read_b128 v[232:235], v12 offset:2048
ds_read_b128 v[236:239], v12 offset:3072
ds_read_b128 v[240:243], v12 offset:4096
s_waitcnt lgkmcnt(15)
v_lshlrev_b32 v126, 16, v116
v_and_b32 v127, 0xffff0000, v116
v_lshlrev_b32 v128, 16, v117
v_and_b32 v129, 0xffff0000, v117
v_lshlrev_b32 v130, 16, v118
v_and_b32 v131, 0xffff0000, v118
v_lshlrev_b32 v132, 16, v119
v_and_b32 v133, 0xffff0000, v119
v_lshlrev_b32 v134, 16, v120
v_and_b32 v135, 0xffff0000, v120
v_lshlrev_b32 v136, 16, v121
v_and_b32 v137, 0xffff0000, v121
v_lshlrev_b32 v138, 16, v122
v_and_b32 v139, 0xffff0000, v122
v_lshlrev_b32 v140, 16, v123
v_and_b32 v141, 0xffff0000, v123
v_lshlrev_b32 v142, 16, v124
v_and_b32 v143, 0xffff0000, v124
v_lshlrev_b32 v144, 16, v125
v_and_b32 v145, 0xffff0000, v125
v_pk_mul_f32 v[126:127], v[126:127], v[96:97]
v_pk_mul_f32 v[128:129], v[128:129], v[98:99]
v_pk_mul_f32 v[130:131], v[130:131], v[100:101]
v_pk_mul_f32 v[132:133], v[132:133], v[102:103]
v_pk_mul_f32 v[134:135], v[134:135], v[104:105]
v_pk_mul_f32 v[136:137], v[136:137], v[106:107]
v_pk_mul_f32 v[138:139], v[138:139], v[108:109]
v_pk_mul_f32 v[140:141], v[140:141], v[110:111]
v_pk_mul_f32 v[142:143], v[142:143], v[112:113]
v_pk_mul_f32 v[144:145], v[144:145], v[114:115]
s_waitcnt lgkmcnt(10)
v_pk_add_f32 v[164:165], v[164:165], v[184:185]
v_pk_add_f32 v[166:167], v[166:167], v[186:187]
v_pk_add_f32 v[168:169], v[168:169], v[188:189]
v_pk_add_f32 v[170:171], v[170:171], v[190:191]
v_pk_add_f32 v[172:173], v[172:173], v[192:193]
v_pk_add_f32 v[174:175], v[174:175], v[194:195]
v_pk_add_f32 v[176:177], v[176:177], v[196:197]
v_pk_add_f32 v[178:179], v[178:179], v[198:199]
v_pk_add_f32 v[180:181], v[180:181], v[200:201]
v_pk_add_f32 v[182:183], v[182:183], v[202:203]
s_waitcnt lgkmcnt(5)
v_pk_add_f32 v[164:165], v[164:165], v[204:205]
v_pk_add_f32 v[166:167], v[166:167], v[206:207]
v_pk_add_f32 v[168:169], v[168:169], v[208:209]
v_pk_add_f32 v[170:171], v[170:171], v[210:211]
v_pk_add_f32 v[172:173], v[172:173], v[212:213]
v_pk_add_f32 v[174:175], v[174:175], v[214:215]
v_pk_add_f32 v[176:177], v[176:177], v[216:217]
v_pk_add_f32 v[178:179], v[178:179], v[218:219]
v_pk_add_f32 v[180:181], v[180:181], v[220:221]
v_pk_add_f32 v[182:183], v[182:183], v[222:223]
s_waitcnt lgkmcnt(0)
v_pk_add_f32 v[164:165], v[164:165], v[224:225]
v_pk_add_f32 v[166:167], v[166:167], v[226:227]
v_pk_add_f32 v[168:169], v[168:169], v[228:229]
v_pk_add_f32 v[170:171], v[170:171], v[230:231]
v_pk_add_f32 v[172:173], v[172:173], v[232:233]
v_pk_add_f32 v[174:175], v[174:175], v[234:235]
v_pk_add_f32 v[176:177], v[176:177], v[236:237]
v_pk_add_f32 v[178:179], v[178:179], v[238:239]
v_pk_add_f32 v[180:181], v[180:181], v[240:241]
v_pk_add_f32 v[182:183], v[182:183], v[242:243]
v_pk_fma_f32 v[164:165], v[164:165], v[2:3], v[126:127]
v_pk_fma_f32 v[166:167], v[166:167], v[2:3], v[128:129]
v_pk_fma_f32 v[168:169], v[168:169], v[2:3], v[130:131]
v_pk_fma_f32 v[170:171], v[170:171], v[2:3], v[132:133]
v_pk_fma_f32 v[172:173], v[172:173], v[2:3], v[134:135]
v_pk_fma_f32 v[174:175], v[174:175], v[2:3], v[136:137]
v_pk_fma_f32 v[176:177], v[176:177], v[2:3], v[138:139]
v_pk_fma_f32 v[178:179], v[178:179], v[2:3], v[140:141]
v_pk_fma_f32 v[180:181], v[180:181], v[2:3], v[142:143]
v_pk_fma_f32 v[182:183], v[182:183], v[2:3], v[144:145]
v_cvt_pk_bf16_f32 v116, v164, v165
v_cvt_pk_bf16_f32 v117, v166, v167
v_cvt_pk_bf16_f32 v118, v168, v169
v_cvt_pk_bf16_f32 v119, v170, v171
buffer_store_dwordx4 v[116:119], v15, s[24:27], s100 offen
v_cvt_pk_bf16_f32 v120, v172, v173
v_cvt_pk_bf16_f32 v121, v174, v175
v_cvt_pk_bf16_f32 v122, v176, v177
v_cvt_pk_bf16_f32 v123, v178, v179
buffer_store_dwordx4 v[120:123], v15, s[24:27], s100 offen offset:16
v_cvt_pk_bf16_f32 v124, v180, v181
v_cvt_pk_bf16_f32 v125, v182, v183
buffer_store_dwordx2 v[124:125], v15, s[24:27], s100 offen offset:32
s_endpgm
KP:
s_lshl3_add_u32 s66, s64, s65
v_mov_b32 v4, 0
v_and_b32 v5, 31, v0
v_lshlrev_b32 v5, 2, v5
v_add_u32 v5, 163712, v5
v_lshlrev_b32 v1, 4, v0
ds_write_b32 v5, v4
s_lshr_b32 s86, s3, 1
s_lshl2_add_u32 s83, s66, s86
s_add_u32 s83, s83, 384
s_and_b32 s82, s3, 1
s_mul_i32 s86, s86, 21216
s_add_u32 s86, s86, 61440
s_cmp_ge_u32 s3, 5
s_cbranch_scc1 KP_W
s_lshr_b32 s67, s66, 1
s_and_b32 s68, s66, 1
s_mul_i32 s68, s68, 5
s_add_u32 s68, s68, s3
v_and_b32 v2, 7, v0
v_lshrrev_b32 v3, 3, v0
s_mul_i32 s72, s67, 81920
s_lshl_b32 s73, s68, 7
s_add_u32 s72, s72, s73
s_lshl_b32 s73, s68, 9
s_movk_i32 s74, 5120
v_mul_u32_u24 v4, 10240, v3
v_lshl_add_u32 v4, v2, 4, v4
v_add_u32 v4, s72, v4
v_lshlrev_b32 v6, 6, v2
v_subrev_u32 v5, 3840, v4
v_cmp_gt_u32 vcc, 3840, v4
v_mov_b32 v7, 0x80000000
s_mov_b32 s18, 2621440
s_mov_b32 s19, 0x20000
s_mov_b32 s10, 2621440
s_mov_b32 s11, 0x20000
s_movk_i32 s30, 5120
s_mov_b32 s31, 0x20000
v_cndmask_b32 v5, v5, v7, vcc
s_waitcnt lgkmcnt(0)
s_mov_b32 s16, s34
s_mov_b32 s17, s35
s_mov_b32 s28, s38
s_mov_b32 s29, s39
s_mov_b32 s8, s36
s_mov_b32 s9, s37
buffer_load_dwordx4 v[32:35], v5, s[16:19], 0 offen offset:0
buffer_load_dwordx4 v[36:39], v5, s[16:19], 0 offen offset:1280
buffer_load_dwordx4 v[40:43], v5, s[16:19], 0 offen offset:2560
buffer_load_dwordx4 v[44:47], v4, s[16:19], 0 offen offset:0
buffer_load_dwordx4 v[48:51], v4, s[16:19], 0 offen offset:1280
buffer_load_dwordx4 v[52:55], v4, s[16:19], 0 offen offset:2560
buffer_load_dwordx4 v[56:59], v4, s[16:19], 0 offen offset:3840
buffer_load_dwordx4 v[60:63], v4, s[16:19], s74 offen offset:0
buffer_load_dwordx4 v[64:67], v4, s[16:19], s74 offen offset:1280
buffer_load_dwordx4 v[68:71], v4, s[16:19], s74 offen offset:2560
buffer_load_dwordx4 v[72:75], v4, s[16:19], s74 offen offset:3840
buffer_load_dwordx4 v[16:19], v6, s[28:31], s73 offen offset:0
buffer_load_dwordx4 v[20:23], v6, s[28:31], s73 offen offset:16
buffer_load_dwordx4 v[24:27], v6, s[28:31], s73 offen offset:32
buffer_load_dwordx4 v[28:31], v6, s[28:31], s73 offen offset:48
buffer_load_dwordx4 v[76:79], v4, s[8:11], 0 offen offset:0
buffer_load_dwordx4 v[80:83], v4, s[8:11], 0 offen offset:1280
buffer_load_dwordx4 v[84:87], v4, s[8:11], 0 offen offset:2560
buffer_load_dwordx4 v[88:91], v4, s[8:11], 0 offen offset:3840
buffer_load_dwordx4 v[92:95], v4, s[8:11], s74 offen offset:0
buffer_load_dwordx4 v[96:99], v4, s[8:11], s74 offen offset:1280
buffer_load_dwordx4 v[100:103], v4, s[8:11], s74 offen offset:2560
buffer_load_dwordx4 v[104:107], v4, s[8:11], s74 offen offset:3840
s_load_dword s96, s[62:63], 0
s_mov_b32 s12, s62
s_mov_b32 s13, s63
s_mov_b32 s14, 268435456
s_mov_b32 s15, 0x20000
s_lshl_b32 s75, s3, 13
v_sub_u32 v7, 7, v3
v_xor_b32 v7, v7, v2
v_lshlrev_b32 v7, 4, v7
v_lshl_add_u32 v7, v2, 7, v7
v_add_u32 v7, s75, v7
v_xor_b32 v8, v2, v3
v_lshlrev_b32 v8, 4, v8
v_lshl_add_u32 v8, v3, 7, v8
v_add_u32 v8, s75, v8
v_lshlrev_b32 v9, 15, v3
v_lshl_add_u32 v9, v2, 4, v9
s_lshl_b32 s75, s68, 18
s_lshl_b32 s76, s67, 7
s_sub_u32 s75, s75, s76
s_add_u32 s75, s75, 8064
v_mul_u32_u24 v10, 43520, v0
s_mul_i32 s80, s68, 4352
s_lshl2_add_u32 s80, s67, s80
s_add_u32 s80, s80, 14110720
s_mov_b32 s76, 0x05040100
s_mov_b32 s77, 0x07060302
s_waitcnt lgkmcnt(0)
s_add_u32 s96, s96, 0x9e3779b9
s_waitcnt vmcnt(8)
v_perm_b32 v172, v32, v36, s76
v_perm_b32 v173, v36, v40, s76
v_perm_b32 v174, v40, v44, s76
v_perm_b32 v175, v44, v48, s76
v_perm_b32 v176, v48, v52, s76
v_perm_b32 v177, v52, v56, s76
v_perm_b32 v178, v56, v60, s76
v_perm_b32 v179, v60, v64, s76
v_perm_b32 v180, v64, v68, s76
v_perm_b32 v181, v68, v72, s76
v_dot2_f32_bf16 v108, v172, v17, 0
v_dot2_f32_bf16 v109, v173, v17, 0
v_dot2_f32_bf16 v110, v174, v17, 0
v_dot2_f32_bf16 v111, v175, v17, 0
v_dot2_f32_bf16 v112, v176, v17, 0
v_dot2_f32_bf16 v113, v177, v17, 0
v_dot2_f32_bf16 v114, v178, v17, 0
v_dot2_f32_bf16 v115, v179, v17, 0
v_dot2c_f32_bf16 v108, v174, v16
v_dot2c_f32_bf16 v109, v175, v16
v_dot2c_f32_bf16 v110, v176, v16
v_dot2c_f32_bf16 v111, v177, v16
v_dot2c_f32_bf16 v112, v178, v16
v_dot2c_f32_bf16 v113, v179, v16
v_dot2c_f32_bf16 v114, v180, v16
v_dot2c_f32_bf16 v115, v181, v16
v_perm_b32 v172, v32, v36, s77
v_perm_b32 v173, v36, v40, s77
v_perm_b32 v174, v40, v44, s77
v_perm_b32 v175, v44, v48, s77
v_perm_b32 v176, v48, v52, s77
v_perm_b32 v177, v52, v56, s77
v_perm_b32 v178, v56, v60, s77
v_perm_b32 v179, v60, v64, s77
v_perm_b32 v180, v64, v68, s77
v_perm_b32 v181, v68, v72, s77
v_dot2_f32_bf16 v116, v172, v19, 0
v_dot2_f32_bf16 v117, v173, v19, 0
v_dot2_f32_bf16 v118, v174, v19, 0
v_dot2_f32_bf16 v119, v175, v19, 0
v_dot2_f32_bf16 v120, v176, v19, 0
v_dot2_f32_bf16 v121, v177, v19, 0
v_dot2_f32_bf16 v122, v178, v19, 0
v_dot2_f32_bf16 v123, v179, v19, 0
v_dot2c_f32_bf16 v116, v174, v18
v_dot2c_f32_bf16 v117, v175, v18
v_dot2c_f32_bf16 v118, v176, v18
v_dot2c_f32_bf16 v119, v177, v18
v_dot2c_f32_bf16 v120, v178, v18
v_dot2c_f32_bf16 v121, v179, v18
v_dot2c_f32_bf16 v122, v180, v18
v_dot2c_f32_bf16 v123, v181, v18
v_perm_b32 v172, v33, v37, s76
v_perm_b32 v173, v37, v41, s76
v_perm_b32 v174, v41, v45, s76
v_perm_b32 v175, v45, v49, s76
v_perm_b32 v176, v49, v53, s76
v_perm_b32 v177, v53, v57, s76
v_perm_b32 v178, v57, v61, s76
v_perm_b32 v179, v61, v65, s76
v_perm_b32 v180, v65, v69, s76
v_perm_b32 v181, v69, v73, s76
v_dot2_f32_bf16 v124, v172, v21, 0
v_dot2_f32_bf16 v125, v173, v21, 0
v_dot2_f32_bf16 v126, v174, v21, 0
v_dot2_f32_bf16 v127, v175, v21, 0
v_dot2_f32_bf16 v128, v176, v21, 0
v_dot2_f32_bf16 v129, v177, v21, 0
v_dot2_f32_bf16 v130, v178, v21, 0
v_dot2_f32_bf16 v131, v179, v21, 0
v_dot2c_f32_bf16 v124, v174, v20
v_dot2c_f32_bf16 v125, v175, v20
v_dot2c_f32_bf16 v126, v176, v20
v_dot2c_f32_bf16 v127, v177, v20
v_dot2c_f32_bf16 v128, v178, v20
v_dot2c_f32_bf16 v129, v179, v20
v_dot2c_f32_bf16 v130, v180, v20
v_dot2c_f32_bf16 v131, v181, v20
v_perm_b32 v172, v33, v37, s77
v_perm_b32 v173, v37, v41, s77
v_perm_b32 v174, v41, v45, s77
v_perm_b32 v175, v45, v49, s77
v_perm_b32 v176, v49, v53, s77
v_perm_b32 v177, v53, v57, s77
v_perm_b32 v178, v57, v61, s77
v_perm_b32 v179, v61, v65, s77
v_perm_b32 v180, v65, v69, s77
v_perm_b32 v181, v69, v73, s77
v_dot2_f32_bf16 v132, v172, v23, 0
v_dot2_f32_bf16 v133, v173, v23, 0
v_dot2_f32_bf16 v134, v174, v23, 0
v_dot2_f32_bf16 v135, v175, v23, 0
v_dot2_f32_bf16 v136, v176, v23, 0
v_dot2_f32_bf16 v137, v177, v23, 0
v_dot2_f32_bf16 v138, v178, v23, 0
v_dot2_f32_bf16 v139, v179, v23, 0
v_dot2c_f32_bf16 v132, v174, v22
v_dot2c_f32_bf16 v133, v175, v22
v_dot2c_f32_bf16 v134, v176, v22
v_dot2c_f32_bf16 v135, v177, v22
v_dot2c_f32_bf16 v136, v178, v22
v_dot2c_f32_bf16 v137, v179, v22
v_dot2c_f32_bf16 v138, v180, v22
v_dot2c_f32_bf16 v139, v181, v22
v_perm_b32 v172, v34, v38, s76
v_perm_b32 v173, v38, v42, s76
v_perm_b32 v174, v42, v46, s76
v_perm_b32 v175, v46, v50, s76
v_perm_b32 v176, v50, v54, s76
v_perm_b32 v177, v54, v58, s76
v_perm_b32 v178, v58, v62, s76
v_perm_b32 v179, v62, v66, s76
v_perm_b32 v180, v66, v70, s76
v_perm_b32 v181, v70, v74, s76
v_dot2_f32_bf16 v140, v172, v25, 0
v_dot2_f32_bf16 v141, v173, v25, 0
v_dot2_f32_bf16 v142, v174, v25, 0
v_dot2_f32_bf16 v143, v175, v25, 0
v_dot2_f32_bf16 v144, v176, v25, 0
v_dot2_f32_bf16 v145, v177, v25, 0
v_dot2_f32_bf16 v146, v178, v25, 0
v_dot2_f32_bf16 v147, v179, v25, 0
v_dot2c_f32_bf16 v140, v174, v24
v_dot2c_f32_bf16 v141, v175, v24
v_dot2c_f32_bf16 v142, v176, v24
v_dot2c_f32_bf16 v143, v177, v24
v_dot2c_f32_bf16 v144, v178, v24
v_dot2c_f32_bf16 v145, v179, v24
v_dot2c_f32_bf16 v146, v180, v24
v_dot2c_f32_bf16 v147, v181, v24
v_perm_b32 v172, v34, v38, s77
v_perm_b32 v173, v38, v42, s77
v_perm_b32 v174, v42, v46, s77
v_perm_b32 v175, v46, v50, s77
v_perm_b32 v176, v50, v54, s77
v_perm_b32 v177, v54, v58, s77
v_perm_b32 v178, v58, v62, s77
v_perm_b32 v179, v62, v66, s77
v_perm_b32 v180, v66, v70, s77
v_perm_b32 v181, v70, v74, s77
v_dot2_f32_bf16 v148, v172, v27, 0
v_dot2_f32_bf16 v149, v173, v27, 0
v_dot2_f32_bf16 v150, v174, v27, 0
v_dot2_f32_bf16 v151, v175, v27, 0
v_dot2_f32_bf16 v152, v176, v27, 0
v_dot2_f32_bf16 v153, v177, v27, 0
v_dot2_f32_bf16 v154, v178, v27, 0
v_dot2_f32_bf16 v155, v179, v27, 0
v_dot2c_f32_bf16 v148, v174, v26
v_dot2c_f32_bf16 v149, v175, v26
v_dot2c_f32_bf16 v150, v176, v26
v_dot2c_f32_bf16 v151, v177, v26
v_dot2c_f32_bf16 v152, v178, v26
v_dot2c_f32_bf16 v153, v179, v26
v_dot2c_f32_bf16 v154, v180, v26
v_dot2c_f32_bf16 v155, v181, v26
v_perm_b32 v172, v35, v39, s76
v_perm_b32 v173, v39, v43, s76
v_perm_b32 v174, v43, v47, s76
v_perm_b32 v175, v47, v51, s76
v_perm_b32 v176, v51, v55, s76
v_perm_b32 v177, v55, v59, s76
v_perm_b32 v178, v59, v63, s76
v_perm_b32 v179, v63, v67, s76
v_perm_b32 v180, v67, v71, s76
v_perm_b32 v181, v71, v75, s76
v_dot2_f32_bf16 v156, v172, v29, 0
v_dot2_f32_bf16 v157, v173, v29, 0
v_dot2_f32_bf16 v158, v174, v29, 0
v_dot2_f32_bf16 v159, v175, v29, 0
v_dot2_f32_bf16 v160, v176, v29, 0
v_dot2_f32_bf16 v161, v177, v29, 0
v_dot2_f32_bf16 v162, v178, v29, 0
v_dot2_f32_bf16 v163, v179, v29, 0
v_dot2c_f32_bf16 v156, v174, v28
v_dot2c_f32_bf16 v157, v175, v28
v_dot2c_f32_bf16 v158, v176, v28
v_dot2c_f32_bf16 v159, v177, v28
v_dot2c_f32_bf16 v160, v178, v28
v_dot2c_f32_bf16 v161, v179, v28
v_dot2c_f32_bf16 v162, v180, v28
v_dot2c_f32_bf16 v163, v181, v28
v_perm_b32 v172, v35, v39, s77
v_perm_b32 v173, v39, v43, s77
v_perm_b32 v174, v43, v47, s77
v_perm_b32 v175, v47, v51, s77
v_perm_b32 v176, v51, v55, s77
v_perm_b32 v177, v55, v59, s77
v_perm_b32 v178, v59, v63, s77
v_perm_b32 v179, v63, v67, s77
v_perm_b32 v180, v67, v71, s77
v_perm_b32 v181, v71, v75, s77
v_dot2_f32_bf16 v164, v172, v31, 0
v_dot2_f32_bf16 v165, v173, v31, 0
v_dot2_f32_bf16 v166, v174, v31, 0
v_dot2_f32_bf16 v167, v175, v31, 0
v_dot2_f32_bf16 v168, v176, v31, 0
v_dot2_f32_bf16 v169, v177, v31, 0
v_dot2_f32_bf16 v170, v178, v31, 0
v_dot2_f32_bf16 v171, v179, v31, 0
v_dot2c_f32_bf16 v164, v174, v30
v_dot2c_f32_bf16 v165, v175, v30
v_dot2c_f32_bf16 v166, v176, v30
v_dot2c_f32_bf16 v167, v177, v30
v_dot2c_f32_bf16 v168, v178, v30
v_dot2c_f32_bf16 v169, v179, v30
v_dot2c_f32_bf16 v170, v180, v30
v_dot2c_f32_bf16 v171, v181, v30
s_lshl_b32 s84, s83, 12
s_add_u32 s20, s40, s84
s_addc_u32 s21, s41, 0
s_movk_i32 s22, 4096
s_mov_b32 s23, 0x20000
s_mov_b32 s24, s42
s_mov_b32 s25, s43
s_movk_i32 s26, 1280
s_mov_b32 s27, 0x20000
s_lshl_b32 s84, s82, 11
v_lshlrev_b32 v238, 4, v0
v_add_u32 v238, s84, v238
s_lshl_b32 s85, s83, 1
v_mov_b32 v239, 0
buffer_load_dwordx4 v[192:195], v238, s[20:23], 0 offen offset:0
buffer_load_dwordx2 v[196:197], v238, s[20:23], 0 offen offset:16
buffer_load_dwordx4 v[198:201], v238, s[20:23], 0 offen offset:1024
buffer_load_dwordx2 v[202:203], v238, s[20:23], 0 offen offset:1040
buffer_load_ushort v204, v239, s[24:27], s85 offen
s_waitcnt vmcnt(5)
v_lshlrev_b32 v172, 16, v76
v_lshlrev_b32 v173, 16, v80
v_lshlrev_b32 v174, 16, v84
v_lshlrev_b32 v175, 16, v88
v_lshlrev_b32 v176, 16, v92
v_lshlrev_b32 v177, 16, v96
v_lshlrev_b32 v178, 16, v100
v_lshlrev_b32 v179, 16, v104
v_pk_mul_f32 v[108:109], v[108:109], v[172:173]
v_pk_mul_f32 v[110:111], v[110:111], v[174:175]
v_pk_mul_f32 v[112:113], v[112:113], v[176:177]
v_pk_mul_f32 v[114:115], v[114:115], v[178:179]
v_cvt_pk_bf16_f32 v182, v115, v114
v_cvt_pk_bf16_f32 v183, v113, v112
v_cvt_pk_bf16_f32 v184, v111, v110
v_cvt_pk_bf16_f32 v185, v109, v108
ds_write_b128 v7, v[182:185] offset:0
ds_read_b128 v[32:35], v8 offset:0
v_and_b32 v172, 0xffff0000, v76
v_and_b32 v173, 0xffff0000, v80
v_and_b32 v174, 0xffff0000, v84
v_and_b32 v175, 0xffff0000, v88
v_and_b32 v176, 0xffff0000, v92
v_and_b32 v177, 0xffff0000, v96
v_and_b32 v178, 0xffff0000, v100
v_and_b32 v179, 0xffff0000, v104
v_pk_mul_f32 v[116:117], v[116:117], v[172:173]
v_pk_mul_f32 v[118:119], v[118:119], v[174:175]
v_pk_mul_f32 v[120:121], v[120:121], v[176:177]
v_pk_mul_f32 v[122:123], v[122:123], v[178:179]
v_cvt_pk_bf16_f32 v186, v123, v122
v_cvt_pk_bf16_f32 v187, v121, v120
v_cvt_pk_bf16_f32 v188, v119, v118
v_cvt_pk_bf16_f32 v189, v117, v116
ds_write_b128 v7, v[186:189] offset:1024
ds_read_b128 v[36:39], v8 offset:1024
v_lshlrev_b32 v172, 16, v77
v_lshlrev_b32 v173, 16, v81
v_lshlrev_b32 v174, 16, v85
v_lshlrev_b32 v175, 16, v89
v_lshlrev_b32 v176, 16, v93
v_lshlrev_b32 v177, 16, v97
v_lshlrev_b32 v178, 16, v101
v_lshlrev_b32 v179, 16, v105
v_pk_mul_f32 v[124:125], v[124:125], v[172:173]
v_pk_mul_f32 v[126:127], v[126:127], v[174:175]
v_pk_mul_f32 v[128:129], v[128:129], v[176:177]
v_pk_mul_f32 v[130:131], v[130:131], v[178:179]
v_cvt_pk_bf16_f32 v182, v131, v130
v_cvt_pk_bf16_f32 v183, v129, v128
v_cvt_pk_bf16_f32 v184, v127, v126
v_cvt_pk_bf16_f32 v185, v125, v124
s_waitcnt lgkmcnt(2)
buffer_store_dwordx4 v[32:35], v9, s[12:15], s75 offen sc1
s_add_u32 s75, s75, 4096
ds_write_b128 v7, v[182:185] offset:2048
ds_read_b128 v[40:43], v8 offset:2048
v_and_b32 v172, 0xffff0000, v77
v_and_b32 v173, 0xffff0000, v81
v_and_b32 v174, 0xffff0000, v85
v_and_b32 v175, 0xffff0000, v89
v_and_b32 v176, 0xffff0000, v93
v_and_b32 v177, 0xffff0000, v97
v_and_b32 v178, 0xffff0000, v101
v_and_b32 v179, 0xffff0000, v105
v_pk_mul_f32 v[132:133], v[132:133], v[172:173]
v_pk_mul_f32 v[134:135], v[134:135], v[174:175]
v_pk_mul_f32 v[136:137], v[136:137], v[176:177]
v_pk_mul_f32 v[138:139], v[138:139], v[178:179]
v_cvt_pk_bf16_f32 v186, v139, v138
v_cvt_pk_bf16_f32 v187, v137, v136
v_cvt_pk_bf16_f32 v188, v135, v134
v_cvt_pk_bf16_f32 v189, v133, v132
s_waitcnt lgkmcnt(2)
buffer_store_dwordx4 v[36:39], v9, s[12:15], s75 offen sc1
s_add_u32 s75, s75, 4096
ds_write_b128 v7, v[186:189] offset:3072
ds_read_b128 v[44:47], v8 offset:3072
v_lshlrev_b32 v172, 16, v78
v_lshlrev_b32 v173, 16, v82
v_lshlrev_b32 v174, 16, v86
v_lshlrev_b32 v175, 16, v90
v_lshlrev_b32 v176, 16, v94
v_lshlrev_b32 v177, 16, v98
v_lshlrev_b32 v178, 16, v102
v_lshlrev_b32 v179, 16, v106
v_pk_mul_f32 v[140:141], v[140:141], v[172:173]
v_pk_mul_f32 v[142:143], v[142:143], v[174:175]
v_pk_mul_f32 v[144:145], v[144:145], v[176:177]
v_pk_mul_f32 v[146:147], v[146:147], v[178:179]
v_cvt_pk_bf16_f32 v182, v147, v146
v_cvt_pk_bf16_f32 v183, v145, v144
v_cvt_pk_bf16_f32 v184, v143, v142
v_cvt_pk_bf16_f32 v185, v141, v140
s_waitcnt lgkmcnt(2)
buffer_store_dwordx4 v[40:43], v9, s[12:15], s75 offen sc1
s_add_u32 s75, s75, 4096
ds_write_b128 v7, v[182:185] offset:4096
ds_read_b128 v[48:51], v8 offset:4096
v_and_b32 v172, 0xffff0000, v78
v_and_b32 v173, 0xffff0000, v82
v_and_b32 v174, 0xffff0000, v86
v_and_b32 v175, 0xffff0000, v90
v_and_b32 v176, 0xffff0000, v94
v_and_b32 v177, 0xffff0000, v98
v_and_b32 v178, 0xffff0000, v102
v_and_b32 v179, 0xffff0000, v106
v_pk_mul_f32 v[148:149], v[148:149], v[172:173]
v_pk_mul_f32 v[150:151], v[150:151], v[174:175]
v_pk_mul_f32 v[152:153], v[152:153], v[176:177]
v_pk_mul_f32 v[154:155], v[154:155], v[178:179]
v_cvt_pk_bf16_f32 v186, v155, v154
v_cvt_pk_bf16_f32 v187, v153, v152
v_cvt_pk_bf16_f32 v188, v151, v150
v_cvt_pk_bf16_f32 v189, v149, v148
s_waitcnt lgkmcnt(2)
buffer_store_dwordx4 v[44:47], v9, s[12:15], s75 offen sc1
s_add_u32 s75, s75, 4096
ds_write_b128 v7, v[186:189] offset:5120
ds_read_b128 v[52:55], v8 offset:5120
v_lshlrev_b32 v172, 16, v79
v_lshlrev_b32 v173, 16, v83
v_lshlrev_b32 v174, 16, v87
v_lshlrev_b32 v175, 16, v91
v_lshlrev_b32 v176, 16, v95
v_lshlrev_b32 v177, 16, v99
v_lshlrev_b32 v178, 16, v103
v_lshlrev_b32 v179, 16, v107
v_pk_mul_f32 v[156:157], v[156:157], v[172:173]
v_pk_mul_f32 v[158:159], v[158:159], v[174:175]
v_pk_mul_f32 v[160:161], v[160:161], v[176:177]
v_pk_mul_f32 v[162:163], v[162:163], v[178:179]
v_cvt_pk_bf16_f32 v182, v163, v162
v_cvt_pk_bf16_f32 v183, v161, v160
v_cvt_pk_bf16_f32 v184, v159, v158
v_cvt_pk_bf16_f32 v185, v157, v156
s_waitcnt lgkmcnt(2)
buffer_store_dwordx4 v[48:51], v9, s[12:15], s75 offen sc1
s_add_u32 s75, s75, 4096
ds_write_b128 v7, v[182:185] offset:6144
ds_read_b128 v[56:59], v8 offset:6144
v_and_b32 v172, 0xffff0000, v79
v_and_b32 v173, 0xffff0000, v83
v_and_b32 v174, 0xffff0000, v87
v_and_b32 v175, 0xffff0000, v91
v_and_b32 v176, 0xffff0000, v95
v_and_b32 v177, 0xffff0000, v99
v_and_b32 v178, 0xffff0000, v103
v_and_b32 v179, 0xffff0000, v107
v_pk_mul_f32 v[164:165], v[164:165], v[172:173]
v_pk_mul_f32 v[166:167], v[166:167], v[174:175]
v_pk_mul_f32 v[168:169], v[168:169], v[176:177]
v_pk_mul_f32 v[170:171], v[170:171], v[178:179]
v_cvt_pk_bf16_f32 v186, v171, v170
v_cvt_pk_bf16_f32 v187, v169, v168
v_cvt_pk_bf16_f32 v188, v167, v166
v_cvt_pk_bf16_f32 v189, v165, v164
s_waitcnt lgkmcnt(2)
buffer_store_dwordx4 v[52:55], v9, s[12:15], s75 offen sc1
s_add_u32 s75, s75, 4096
ds_write_b128 v7, v[186:189] offset:7168
ds_read_b128 v[60:63], v8 offset:7168
s_waitcnt lgkmcnt(2)
buffer_store_dwordx4 v[56:59], v9, s[12:15], s75 offen sc1
s_add_u32 s75, s75, 4096
s_waitcnt lgkmcnt(0)
buffer_store_dwordx4 v[60:63], v9, s[12:15], s75 offen sc1
s_waitcnt vmcnt(8)
v_mov_b32 v206, 0
v_mov_b32 v207, 0
v_mov_b32 v208, 0
v_mov_b32 v209, 0
v_bfe_u32 v210, v0, 1, 2
v_mul_u32_u24 v210, 4160, v210
v_and_b32 v211, 1, v0
v_lshl_add_u32 v210, v211, 4, v210
v_min_u32 v211, 29, v0
v_lshlrev_b32 v211, 4, v211
v_add_u32 v211, 20736, v211
s_cmp_eq_u32 s82, 0
s_cselect_b64 vcc, -1, 0
s_cselect_b64 s[88:89], 1, 0
v_cndmask_b32 v210, v211, v210, vcc
v_add_u32 v210, s86, v210
ds_write_b128 v210, v[206:209]
s_lshl_b32 s84, s82, 11
s_add_u32 s84, s84, s86
v_lshlrev_b32 v210, 4, v0
v_add_u32 v210, s84, v210
v_lshlrev_b32 v211, 16, v204
v_lshlrev_b32 v212, 16, v192
v_add_f32 v211, v211, v212
v_and_b32 v212, 0xffff0000, v192
v_cvt_pk_bf16_f32 v211, v211, v212
s_nop 0
v_cndmask_b32 v192, v192, v211, s[88:89]
ds_write_b128 v210, v[192:195] offset:32
v_alignbit_b32 v214, v193, v192, 16
v_alignbit_b32 v215, v194, v193, 16
v_alignbit_b32 v216, v195, v194, 16
v_alignbit_b32 v217, v196, v195, 16
ds_write_b128 v210, v[214:217] offset:4192
v_mov_b32 v218, v193
v_mov_b32 v219, v194
v_mov_b32 v220, v195
v_mov_b32 v221, v196
ds_write_b128 v210, v[218:221] offset:8352
v_alignbit_b32 v222, v194, v193, 16
v_alignbit_b32 v223, v195, v194, 16
v_alignbit_b32 v224, v196, v195, 16
v_alignbit_b32 v225, v197, v196, 16
ds_write_b128 v210, v[222:225] offset:12512
v_lshlrev_b32 v212, 16, v192
v_mov_b32 v213, v214
s_mov_b64 exec, s[88:89]
ds_write_b32 v210, v212 offset:4188
ds_write_b32 v210, v192 offset:8348
ds_write_b64 v210, v[212:213] offset:12504
s_mov_b64 exec, -1
ds_write_b128 v210, v[198:201] offset:1056
v_alignbit_b32 v226, v199, v198, 16
v_alignbit_b32 v227, v200, v199, 16
v_alignbit_b32 v228, v201, v200, 16
v_alignbit_b32 v229, v202, v201, 16
ds_write_b128 v210, v[226:229] offset:5216
v_mov_b32 v230, v199
v_mov_b32 v231, v200
v_mov_b32 v232, v201
v_mov_b32 v233, v202
ds_write_b128 v210, v[230:233] offset:9376
v_alignbit_b32 v234, v200, v199, 16
v_alignbit_b32 v235, v201, v200, 16
v_alignbit_b32 v236, v202, v201, 16
v_alignbit_b32 v237, v203, v202, 16
ds_write_b128 v210, v[234:237] offset:13536
v_mov_b32 v11, s96
s_mov_b64 exec, 255
s_waitcnt vmcnt(0)
buffer_store_dword v11, v10, s[12:15], s80 offen sc1
s_mov_b64 exec, -1
s_waitcnt lgkmcnt(0)
s_branch KP_J
KP_W:
s_waitcnt lgkmcnt(0)
s_load_dword s96, s[62:63], 0
s_lshl_b32 s84, s83, 12
s_add_u32 s20, s40, s84
s_addc_u32 s21, s41, 0
s_movk_i32 s22, 4096
s_mov_b32 s23, 0x20000
s_mov_b32 s24, s42
s_mov_b32 s25, s43
s_movk_i32 s26, 1280
s_mov_b32 s27, 0x20000
s_lshl_b32 s84, s82, 11
v_lshlrev_b32 v238, 4, v0
v_add_u32 v238, s84, v238
s_lshl_b32 s85, s83, 1
v_mov_b32 v239, 0
buffer_load_dwordx4 v[192:195], v238, s[20:23], 0 offen offset:0
buffer_load_dwordx2 v[196:197], v238, s[20:23], 0 offen offset:16
buffer_load_dwordx4 v[198:201], v238, s[20:23], 0 offen offset:1024
buffer_load_dwordx2 v[202:203], v238, s[20:23], 0 offen offset:1040
buffer_load_ushort v204, v239, s[24:27], s85 offen
s_mov_b32 s12, s62
s_mov_b32 s13, s63
s_mov_b32 s14, 268435456
s_mov_b32 s15, 0x20000
s_lshr_b32 s72, s64, 1
s_lshl3_add_u32 s72, s72, s71
s_lshr_b32 s73, s65, 2
s_lshl1_add_u32 s72, s72, s73
s_mul_i32 s72, s72, 8704
s_add_u32 s72, s72, 14458880
v_min_u32 v2, 47, v0
v_cmp_lt_u32 vcc, 23, v2
v_lshlrev_b32 v2, 2, v2
v_add_u32 v3, 4256, v2
v_cndmask_b32 v2, v2, v3, vcc
s_lshl1_add_u32 s73, s71, s73
s_mul_i32 s73, s73, 122880
s_mul_i32 s74, s3, 40960
s_add_u32 s73, s73, s74
s_add_u32 s73, s73, 5042176
v_lshlrev_b32 v3, 7, v0
s_waitcnt lgkmcnt(0)
s_add_u32 s96, s96, 0x9e3779b9
s_waitcnt vmcnt(0)
v_mov_b32 v206, 0
v_mov_b32 v207, 0
v_mov_b32 v208, 0
v_mov_b32 v209, 0
v_bfe_u32 v210, v0, 1, 2
v_mul_u32_u24 v210, 4160, v210
v_and_b32 v211, 1, v0
v_lshl_add_u32 v210, v211, 4, v210
v_min_u32 v211, 29, v0
v_lshlrev_b32 v211, 4, v211
v_add_u32 v211, 20736, v211
s_cmp_eq_u32 s82, 0
s_cselect_b64 vcc, -1, 0
s_cselect_b64 s[88:89], 1, 0
v_cndmask_b32 v210, v211, v210, vcc
v_add_u32 v210, s86, v210
ds_write_b128 v210, v[206:209]
s_lshl_b32 s84, s82, 11
s_add_u32 s84, s84, s86
v_lshlrev_b32 v210, 4, v0
v_add_u32 v210, s84, v210
v_lshlrev_b32 v211, 16, v204
v_lshlrev_b32 v212, 16, v192
v_add_f32 v211, v211, v212
v_and_b32 v212, 0xffff0000, v192
v_cvt_pk_bf16_f32 v211, v211, v212
s_nop 0
v_cndmask_b32 v192, v192, v211, s[88:89]
ds_write_b128 v210, v[192:195] offset:32
v_alignbit_b32 v214, v193, v192, 16
v_alignbit_b32 v215, v194, v193, 16
v_alignbit_b32 v216, v195, v194, 16
v_alignbit_b32 v217, v196, v195, 16
ds_write_b128 v210, v[214:217] offset:4192
v_mov_b32 v218, v193
v_mov_b32 v219, v194
v_mov_b32 v220, v195
v_mov_b32 v221, v196
ds_write_b128 v210, v[218:221] offset:8352
v_alignbit_b32 v222, v194, v193, 16
v_alignbit_b32 v223, v195, v194, 16
v_alignbit_b32 v224, v196, v195, 16
v_alignbit_b32 v225, v197, v196, 16
ds_write_b128 v210, v[222:225] offset:12512
v_lshlrev_b32 v212, 16, v192
v_mov_b32 v213, v214
s_mov_b64 exec, s[88:89]
ds_write_b32 v210, v212 offset:4188
ds_write_b32 v210, v192 offset:8348
ds_write_b64 v210, v[212:213] offset:12504
s_mov_b64 exec, -1
ds_write_b128 v210, v[198:201] offset:1056
v_alignbit_b32 v226, v199, v198, 16
v_alignbit_b32 v227, v200, v199, 16
v_alignbit_b32 v228, v201, v200, 16
v_alignbit_b32 v229, v202, v201, 16
ds_write_b128 v210, v[226:229] offset:5216
v_mov_b32 v230, v199
v_mov_b32 v231, v200
v_mov_b32 v232, v201
v_mov_b32 v233, v202
ds_write_b128 v210, v[230:233] offset:9376
v_alignbit_b32 v234, v200, v199, 16
v_alignbit_b32 v235, v201, v200, 16
v_alignbit_b32 v236, v202, v201, 16
v_alignbit_b32 v237, v203, v202, 16
ds_write_b128 v210, v[234:237] offset:13536
s_waitcnt lgkmcnt(0)
KP_J:
s_barrier
s_cmp_lt_u32 s3, 4
s_cbranch_scc1 KP_G0
s_sub_u32 s3, s3, 4
s_sub_u32 s83, s83, 2
s_sub_u32 s86, s86, 42432
s_mul_i32 s94, s64, 10
s_lshr_b32 s87, s83, 6
s_add_u32 s94, s94, s87
s_mul_i32 s94, s94, 4352
s_add_u32 s94, s94, 14110720
v_and_b32 v5, 31, v0
v_lshlrev_b32 v5, 2, v5
buffer_load_dword v4, v5, s[12:15], s94 offen sc1
v_and_b32 v9, 15, v0
v_add_u32 v10, 1, v9
v_and_b32 v11, 3, v10
v_mul_u32_u24 v12, 4160, v11
s_lshl_b32 s87, s82, 8
s_add_u32 s87, s87, s86
v_and_b32 v10, 28, v10
v_lshl_add_u32 v12, v10, 1, v12
v_and_b32 v11, 48, v0
v_add3_u32 v12, v12, v11, s87
v_add_u32 v13, 2048, v12
v_lshlrev_b32 v9, 5, v9
v_sub_u32 v14, v11, v9
s_add_u32 s87, s87, 17120
v_add_u32 v14, s87, v14
ds_read2_b64 v[128:131], v12 offset0:0 offset1:1
ds_read2_b64 v[132:135], v12 offset0:64 offset1:65
ds_read2_b64 v[136:139], v12 offset0:128 offset1:129
ds_read2_b64 v[140:143], v12 offset0:192 offset1:193
ds_read2_b64 v[144:147], v13 offset0:0 offset1:1
ds_read2_b64 v[148:151], v13 offset0:64 offset1:65
ds_read2_b64 v[152:155], v13 offset0:128 offset1:129
ds_read2_b64 v[156:159], v13 offset0:192 offset1:193
s_mov_b32 s97, 0
s_waitcnt vmcnt(0)
v_cmp_ne_u32 vcc, s96, v4
s_nop 1
s_cbranch_vccz KP_up_done
KP_up_loop:
buffer_load_dword v4, v5, s[12:15], s94 offen sc1
s_add_u32 s97, s97, 1
s_waitcnt vmcnt(0)
v_cmp_ne_u32 vcc, s96, v4
s_cmp_ge_u32 s97, 32768
s_cbranch_scc1 KP_up_done
s_cbranch_vccnz KP_up_loop
KP_up_done:
s_add_u32 m0, s86, 16640
s_lshl_b32 s87, s83, 12
s_add_u32 s87, s87, 4096
buffer_load_dwordx4 v1, s[12:15], s87 offen offset:0 lds
buffer_load_dwordx4 v1, s[12:15], s87 offen offset:1024 lds
buffer_load_dwordx4 v1, s[12:15], s87 offen offset:2048 lds
buffer_load_dwordx4 v1, s[12:15], s87 offen offset:3072 lds
s_add_u32 m0, m0, 42432
s_add_u32 s87, s87, 8192
buffer_load_dwordx4 v1, s[12:15], s87 offen offset:0 lds
buffer_load_dwordx4 v1, s[12:15], s87 offen offset:1024 lds
buffer_load_dwordx4 v1, s[12:15], s87 offen offset:2048 lds
buffer_load_dwordx4 v1, s[12:15], s87 offen offset:3072 lds
s_mul_i32 s76, s3, 5120
s_add_u32 s76, s76, 40960
s_xor_b32 s77, s3, 1
s_mul_i32 s77, s77, 5120
s_add_u32 s77, s77, 40960
s_waitcnt vmcnt(4)
ds_read_b128 v[160:163], v14 offset:3584
ds_read_b128 v[164:167], v14 offset:3072
ds_read_b128 v[168:171], v14 offset:2560
ds_read_b128 v[172:175], v14 offset:2048
ds_read_b128 v[176:179], v14 offset:1536
ds_read_b128 v[180:183], v14 offset:1024
ds_read_b128 v[184:187], v14 offset:512
ds_read_b128 v[188:191], v14 offset:0
s_setprio 1
s_waitcnt lgkmcnt(0)
v_mfma_f32_16x16x32_bf16 v[220:223], v[140:143], v[176:179], 0
ds_read2_b64 v[64:67], v12 offset0:8 offset1:9
v_mfma_f32_16x16x32_bf16 v[216:219], v[140:143], v[172:175], 0
ds_read_b128 v[96:99], v14 offset:3648
v_mfma_f32_16x16x32_bf16 v[212:215], v[136:139], v[172:175], 0
v_mfma_f32_16x16x32_bf16 v[208:211], v[136:139], v[168:171], 0
ds_read2_b64 v[68:71], v12 offset0:72 offset1:73
v_mfma_f32_16x16x32_bf16 v[220:223], v[144:147], v[172:175], v[220:223]
ds_read_b128 v[100:103], v14 offset:3136
v_mfma_f32_16x16x32_bf16 v[216:219], v[136:139], v[176:179], v[216:219]
v_mfma_f32_16x16x32_bf16 v[212:215], v[140:143], v[168:171], v[212:215]
ds_read2_b64 v[72:75], v12 offset0:136 offset1:137
v_mfma_f32_16x16x32_bf16 v[204:207], v[132:135], v[168:171], 0
ds_read_b128 v[104:107], v14 offset:2624
v_mfma_f32_16x16x32_bf16 v[220:223], v[136:139], v[180:183], v[220:223]
v_mfma_f32_16x16x32_bf16 v[216:219], v[144:147], v[168:171], v[216:219]
ds_read2_b64 v[76:79], v12 offset0:200 offset1:201
v_mfma_f32_16x16x32_bf16 v[208:211], v[132:135], v[172:175], v[208:211]
ds_read_b128 v[108:111], v14 offset:2112
v_mfma_f32_16x16x32_bf16 v[212:215], v[132:135], v[176:179], v[212:215]
v_mfma_f32_16x16x32_bf16 v[220:223], v[148:151], v[168:171], v[220:223]
ds_read2_b64 v[80:83], v13 offset0:8 offset1:9
v_mfma_f32_16x16x32_bf16 v[216:219], v[132:135], v[180:183], v[216:219]
ds_read_b128 v[112:115], v14 offset:1600
v_mfma_f32_16x16x32_bf16 v[200:203], v[132:135], v[164:167], 0
v_mfma_f32_16x16x32_bf16 v[204:207], v[136:139], v[164:167], v[204:207]
ds_read2_b64 v[84:87], v13 offset0:72 offset1:73
v_mfma_f32_16x16x32_bf16 v[220:223], v[132:135], v[184:187], v[220:223]
ds_read_b128 v[116:119], v14 offset:1088
v_mfma_f32_16x16x32_bf16 v[208:211], v[140:143], v[164:167], v[208:211]
v_mfma_f32_16x16x32_bf16 v[212:215], v[144:147], v[164:167], v[212:215]
ds_read2_b64 v[88:91], v13 offset0:136 offset1:137
v_mfma_f32_16x16x32_bf16 v[216:219], v[148:151], v[164:167], v[216:219]
ds_read_b128 v[120:123], v14 offset:576
v_mfma_f32_16x16x32_bf16 v[220:223], v[152:155], v[164:167], v[220:223]
v_mfma_f32_16x16x32_bf16 v[196:199], v[128:131], v[164:167], 0
ds_read2_b64 v[92:95], v13 offset0:200 offset1:201
v_mfma_f32_16x16x32_bf16 v[200:203], v[128:131], v[168:171], v[200:203]
ds_read_b128 v[124:127], v14 offset:64
v_mfma_f32_16x16x32_bf16 v[204:207], v[128:131], v[172:175], v[204:207]
v_mfma_f32_16x16x32_bf16 v[208:211], v[128:131], v[176:179], v[208:211]
v_mfma_f32_16x16x32_bf16 v[212:215], v[128:131], v[180:183], v[212:215]
v_mfma_f32_16x16x32_bf16 v[216:219], v[128:131], v[184:187], v[216:219]
v_mfma_f32_16x16x32_bf16 v[220:223], v[128:131], v[188:191], v[220:223]
v_mfma_f32_16x16x32_bf16 v[192:195], v[128:131], v[160:163], 0
v_mfma_f32_16x16x32_bf16 v[196:199], v[132:135], v[160:163], v[196:199]
v_mfma_f32_16x16x32_bf16 v[200:203], v[136:139], v[160:163], v[200:203]
v_mfma_f32_16x16x32_bf16 v[204:207], v[140:143], v[160:163], v[204:207]
v_mfma_f32_16x16x32_bf16 v[208:211], v[144:147], v[160:163], v[208:211]
v_mfma_f32_16x16x32_bf16 v[212:215], v[148:151], v[160:163], v[212:215]
v_mfma_f32_16x16x32_bf16 v[216:219], v[152:155], v[160:163], v[216:219]
v_mfma_f32_16x16x32_bf16 v[220:223], v[156:159], v[160:163], v[220:223]
s_waitcnt lgkmcnt(0)
v_mfma_f32_16x16x32_bf16 v[220:223], v[76:79], v[112:115], v[220:223]
ds_read2_b64 v[128:131], v12 offset0:16 offset1:17
v_mfma_f32_16x16x32_bf16 v[216:219], v[76:79], v[108:111], v[216:219]
ds_read_b128 v[160:163], v14 offset:3712
v_mfma_f32_16x16x32_bf16 v[212:215], v[72:75], v[108:111], v[212:215]
v_mfma_f32_16x16x32_bf16 v[208:211], v[72:75], v[104:107], v[208:211]
ds_read2_b64 v[132:135], v12 offset0:80 offset1:81
v_mfma_f32_16x16x32_bf16 v[220:223], v[80:83], v[108:111], v[220:223]
ds_read_b128 v[164:167], v14 offset:3200
v_mfma_f32_16x16x32_bf16 v[216:219], v[72:75], v[112:115], v[216:219]
v_mfma_f32_16x16x32_bf16 v[212:215], v[76:79], v[104:107], v[212:215]
ds_read2_b64 v[136:139], v12 offset0:144 offset1:145
v_mfma_f32_16x16x32_bf16 v[204:207], v[68:71], v[104:107], v[204:207]
ds_read_b128 v[168:171], v14 offset:2688
v_mfma_f32_16x16x32_bf16 v[220:223], v[72:75], v[116:119], v[220:223]
v_mfma_f32_16x16x32_bf16 v[216:219], v[80:83], v[104:107], v[216:219]
ds_read2_b64 v[140:143], v12 offset0:208 offset1:209
v_mfma_f32_16x16x32_bf16 v[208:211], v[68:71], v[108:111], v[208:211]
ds_read_b128 v[172:175], v14 offset:2176
v_mfma_f32_16x16x32_bf16 v[212:215], v[68:71], v[112:115], v[212:215]
v_mfma_f32_16x16x32_bf16 v[220:223], v[84:87], v[104:107], v[220:223]
ds_read2_b64 v[144:147], v13 offset0:16 offset1:17
v_mfma_f32_16x16x32_bf16 v[216:219], v[68:71], v[116:119], v[216:219]
ds_read_b128 v[176:179], v14 offset:1664
v_mfma_f32_16x16x32_bf16 v[200:203], v[68:71], v[100:103], v[200:203]
v_mfma_f32_16x16x32_bf16 v[204:207], v[72:75], v[100:103], v[204:207]
ds_read2_b64 v[148:151], v13 offset0:80 offset1:81
v_mfma_f32_16x16x32_bf16 v[220:223], v[68:71], v[120:123], v[220:223]
ds_read_b128 v[180:183], v14 offset:1152
v_mfma_f32_16x16x32_bf16 v[208:211], v[76:79], v[100:103], v[208:211]
v_mfma_f32_16x16x32_bf16 v[212:215], v[80:83], v[100:103], v[212:215]
ds_read2_b64 v[152:155], v13 offset0:144 offset1:145
v_mfma_f32_16x16x32_bf16 v[216:219], v[84:87], v[100:103], v[216:219]
ds_read_b128 v[184:187], v14 offset:640
v_mfma_f32_16x16x32_bf16 v[220:223], v[88:91], v[100:103], v[220:223]
v_mfma_f32_16x16x32_bf16 v[196:199], v[64:67], v[100:103], v[196:199]
ds_read2_b64 v[156:159], v13 offset0:208 offset1:209
v_mfma_f32_16x16x32_bf16 v[200:203], v[64:67], v[104:107], v[200:203]
ds_read_b128 v[188:191], v14 offset:128
v_mfma_f32_16x16x32_bf16 v[204:207], v[64:67], v[108:111], v[204:207]
v_mfma_f32_16x16x32_bf16 v[208:211], v[64:67], v[112:115], v[208:211]
v_mfma_f32_16x16x32_bf16 v[212:215], v[64:67], v[116:119], v[212:215]
v_mfma_f32_16x16x32_bf16 v[216:219], v[64:67], v[120:123], v[216:219]
v_mfma_f32_16x16x32_bf16 v[220:223], v[64:67], v[124:127], v[220:223]
v_mfma_f32_16x16x32_bf16 v[192:195], v[64:67], v[96:99], v[192:195]
v_mfma_f32_16x16x32_bf16 v[196:199], v[68:71], v[96:99], v[196:199]
v_mfma_f32_16x16x32_bf16 v[200:203], v[72:75], v[96:99], v[200:203]
v_mfma_f32_16x16x32_bf16 v[204:207], v[76:79], v[96:99], v[204:207]
v_mfma_f32_16x16x32_bf16 v[208:211], v[80:83], v[96:99], v[208:211]
v_mfma_f32_16x16x32_bf16 v[212:215], v[84:87], v[96:99], v[212:215]
v_mfma_f32_16x16x32_bf16 v[216:219], v[88:91], v[96:99], v[216:219]
v_mfma_f32_16x16x32_bf16 v[220:223], v[92:95], v[96:99], v[220:223]
s_waitcnt lgkmcnt(0)
v_mfma_f32_16x16x32_bf16 v[220:223], v[140:143], v[176:179], v[220:223]
ds_read2_b64 v[64:67], v12 offset0:24 offset1:25
v_mfma_f32_16x16x32_bf16 v[216:219], v[140:143], v[172:175], v[216:219]
ds_read_b128 v[96:99], v14 offset:3776
v_mfma_f32_16x16x32_bf16 v[212:215], v[136:139], v[172:175], v[212:215]
v_mfma_f32_16x16x32_bf16 v[208:211], v[136:139], v[168:171], v[208:211]
ds_read2_b64 v[68:71], v12 offset0:88 offset1:89
v_mfma_f32_16x16x32_bf16 v[220:223], v[144:147], v[172:175], v[220:223]
ds_read_b128 v[100:103], v14 offset:3264
v_mfma_f32_16x16x32_bf16 v[216:219], v[136:139], v[176:179], v[216:219]
v_mfma_f32_16x16x32_bf16 v[212:215], v[140:143], v[168:171], v[212:215]
ds_read2_b64 v[72:75], v12 offset0:152 offset1:153
v_mfma_f32_16x16x32_bf16 v[204:207], v[132:135], v[168:171], v[204:207]
ds_read_b128 v[104:107], v14 offset:2752
v_mfma_f32_16x16x32_bf16 v[220:223], v[136:139], v[180:183], v[220:223]
v_mfma_f32_16x16x32_bf16 v[216:219], v[144:147], v[168:171], v[216:219]
ds_read2_b64 v[76:79], v12 offset0:216 offset1:217
v_mfma_f32_16x16x32_bf16 v[208:211], v[132:135], v[172:175], v[208:211]
ds_read_b128 v[108:111], v14 offset:2240
v_mfma_f32_16x16x32_bf16 v[212:215], v[132:135], v[176:179], v[212:215]
v_mfma_f32_16x16x32_bf16 v[220:223], v[148:151], v[168:171], v[220:223]
ds_read2_b64 v[80:83], v13 offset0:24 offset1:25
v_mfma_f32_16x16x32_bf16 v[216:219], v[132:135], v[180:183], v[216:219]
ds_read_b128 v[112:115], v14 offset:1728
v_mfma_f32_16x16x32_bf16 v[200:203], v[132:135], v[164:167], v[200:203]
v_mfma_f32_16x16x32_bf16 v[204:207], v[136:139], v[164:167], v[204:207]
ds_read2_b64 v[84:87], v13 offset0:88 offset1:89
v_mfma_f32_16x16x32_bf16 v[220:223], v[132:135], v[184:187], v[220:223]
ds_read_b128 v[116:119], v14 offset:1216
v_mfma_f32_16x16x32_bf16 v[208:211], v[140:143], v[164:167], v[208:211]
v_mfma_f32_16x16x32_bf16 v[212:215], v[144:147], v[164:167], v[212:215]
ds_read2_b64 v[88:91], v13 offset0:152 offset1:153
v_mfma_f32_16x16x32_bf16 v[216:219], v[148:151], v[164:167], v[216:219]
ds_read_b128 v[120:123], v14 offset:704
v_mfma_f32_16x16x32_bf16 v[220:223], v[152:155], v[164:167], v[220:223]
v_mfma_f32_16x16x32_bf16 v[196:199], v[128:131], v[164:167], v[196:199]
ds_read2_b64 v[92:95], v13 offset0:216 offset1:217
v_mfma_f32_16x16x32_bf16 v[200:203], v[128:131], v[168:171], v[200:203]
ds_read_b128 v[124:127], v14 offset:192
v_mfma_f32_16x16x32_bf16 v[204:207], v[128:131], v[172:175], v[204:207]
v_mfma_f32_16x16x32_bf16 v[208:211], v[128:131], v[176:179], v[208:211]
v_mfma_f32_16x16x32_bf16 v[212:215], v[128:131], v[180:183], v[212:215]
v_mfma_f32_16x16x32_bf16 v[216:219], v[128:131], v[184:187], v[216:219]
v_mfma_f32_16x16x32_bf16 v[220:223], v[128:131], v[188:191], v[220:223]
v_mfma_f32_16x16x32_bf16 v[192:195], v[128:131], v[160:163], v[192:195]
v_mfma_f32_16x16x32_bf16 v[196:199], v[132:135], v[160:163], v[196:199]
v_mfma_f32_16x16x32_bf16 v[200:203], v[136:139], v[160:163], v[200:203]
v_mfma_f32_16x16x32_bf16 v[204:207], v[140:143], v[160:163], v[204:207]
v_mfma_f32_16x16x32_bf16 v[208:211], v[144:147], v[160:163], v[208:211]
v_mfma_f32_16x16x32_bf16 v[212:215], v[148:151], v[160:163], v[212:215]
v_mfma_f32_16x16x32_bf16 v[216:219], v[152:155], v[160:163], v[216:219]
v_mfma_f32_16x16x32_bf16 v[220:223], v[156:159], v[160:163], v[220:223]
s_waitcnt lgkmcnt(0)
v_mfma_f32_16x16x32_bf16 v[220:223], v[76:79], v[112:115], v[220:223]
v_mfma_f32_16x16x32_bf16 v[216:219], v[76:79], v[108:111], v[216:219]
v_mfma_f32_16x16x32_bf16 v[212:215], v[72:75], v[108:111], v[212:215]
v_add_u32 v12, 42432, v12
v_add_u32 v13, 42432, v13
v_add_u32 v14, 42432, v14
s_waitcnt vmcnt(0)
v_mfma_f32_16x16x32_bf16 v[208:211], v[72:75], v[104:107], v[208:211]
v_mfma_f32_16x16x32_bf16 v[220:223], v[80:83], v[108:111], v[220:223]
ds_read2_b64 v[128:131], v12 offset0:0 offset1:1
v_mfma_f32_16x16x32_bf16 v[216:219], v[72:75], v[112:115], v[216:219]
v_mfma_f32_16x16x32_bf16 v[212:215], v[76:79], v[104:107], v[212:215]
ds_read_b128 v[160:163], v14 offset:3584
v_mfma_f32_16x16x32_bf16 v[204:207], v[68:71], v[104:107], v[204:207]
v_mfma_f32_16x16x32_bf16 v[220:223], v[72:75], v[116:119], v[220:223]
ds_read2_b64 v[132:135], v12 offset0:64 offset1:65
v_mfma_f32_16x16x32_bf16 v[216:219], v[80:83], v[104:107], v[216:219]
v_mfma_f32_16x16x32_bf16 v[208:211], v[68:71], v[108:111], v[208:211]
ds_read_b128 v[164:167], v14 offset:3072
v_mfma_f32_16x16x32_bf16 v[212:215], v[68:71], v[112:115], v[212:215]
v_mfma_f32_16x16x32_bf16 v[220:223], v[84:87], v[104:107], v[220:223]
ds_read2_b64 v[136:139], v12 offset0:128 offset1:129
v_mfma_f32_16x16x32_bf16 v[216:219], v[68:71], v[116:119], v[216:219]
v_mfma_f32_16x16x32_bf16 v[200:203], v[68:71], v[100:103], v[200:203]
ds_read_b128 v[168:171], v14 offset:2560
v_mfma_f32_16x16x32_bf16 v[204:207], v[72:75], v[100:103], v[204:207]
v_mfma_f32_16x16x32_bf16 v[220:223], v[68:71], v[120:123], v[220:223]
ds_read2_b64 v[140:143], v12 offset0:192 offset1:193
v_mfma_f32_16x16x32_bf16 v[208:211], v[76:79], v[100:103], v[208:211]
v_mfma_f32_16x16x32_bf16 v[212:215], v[80:83], v[100:103], v[212:215]
ds_read_b128 v[172:175], v14 offset:2048
v_mfma_f32_16x16x32_bf16 v[216:219], v[84:87], v[100:103], v[216:219]
v_mfma_f32_16x16x32_bf16 v[220:223], v[88:91], v[100:103], v[220:223]
v_mfma_f32_16x16x32_bf16 v[196:199], v[64:67], v[100:103], v[196:199]
ds_read2_b64 v[144:147], v13 offset0:0 offset1:1
v_mfma_f32_16x16x32_bf16 v[200:203], v[64:67], v[104:107], v[200:203]
v_mfma_f32_16x16x32_bf16 v[204:207], v[64:67], v[108:111], v[204:207]
ds_read_b128 v[176:179], v14 offset:1536
v_mfma_f32_16x16x32_bf16 v[208:211], v[64:67], v[112:115], v[208:211]
v_mfma_f32_16x16x32_bf16 v[212:215], v[64:67], v[116:119], v[212:215]
ds_read2_b64 v[148:151], v13 offset0:64 offset1:65
v_mfma_f32_16x16x32_bf16 v[216:219], v[64:67], v[120:123], v[216:219]
v_mfma_f32_16x16x32_bf16 v[220:223], v[64:67], v[124:127], v[220:223]
ds_read_b128 v[180:183], v14 offset:1024
v_mfma_f32_16x16x32_bf16 v[192:195], v[64:67], v[96:99], v[192:195]
v_mfma_f32_16x16x32_bf16 v[196:199], v[68:71], v[96:99], v[196:199]
ds_read2_b64 v[152:155], v13 offset0:128 offset1:129
v_mfma_f32_16x16x32_bf16 v[200:203], v[72:75], v[96:99], v[200:203]
v_mfma_f32_16x16x32_bf16 v[204:207], v[76:79], v[96:99], v[204:207]
ds_read_b128 v[184:187], v14 offset:512
v_mfma_f32_16x16x32_bf16 v[208:211], v[80:83], v[96:99], v[208:211]
v_mfma_f32_16x16x32_bf16 v[212:215], v[84:87], v[96:99], v[212:215]
ds_read2_b64 v[156:159], v13 offset0:192 offset1:193
v_mfma_f32_16x16x32_bf16 v[216:219], v[88:91], v[96:99], v[216:219]
v_mfma_f32_16x16x32_bf16 v[220:223], v[92:95], v[96:99], v[220:223]
ds_read_b128 v[188:191], v14 offset:0
v_add_u32 v4, s77, v1
v_add_u32 v5, s76, v1
s_lshl_b32 s84, s3, 2
s_add_u32 s84, s84, 163712
v_mov_b32 v6, s84
v_xor_b32 v7, 4, v6
v_mov_b32 v8, 1
v_and_b32 v9, 15, v0
v_lshlrev_b32 v9, 5, v9
v_lshrrev_b32 v10, 4, v0
v_lshl_add_u32 v9, v10, 3, v9
v_add_u32 v9, s76, v9
s_lshl_b32 s84, s83, 12
s_lshl_b32 s85, s82, 11
s_add_u32 s84, s84, s85
s_add_u32 s84, s84, 2625536
s_cmp_eq_u32 s82, 0
s_cbranch_scc0 KP_x1_h1
ds_write_b128 v4, v[208:211] offset:0
ds_write_b128 v4, v[212:215] offset:1024
ds_write_b128 v4, v[216:219] offset:2048
ds_write_b128 v4, v[220:223] offset:3072
s_waitcnt lgkmcnt(0)
ds_write_b32 v6, v8
s_branch KP_x1_j
KP_x1_h1:
ds_write_b128 v4, v[192:195] offset:0
ds_write_b128 v4, v[196:199] offset:1024
ds_write_b128 v4, v[200:203] offset:2048
ds_write_b128 v4, v[204:207] offset:3072
s_waitcnt lgkmcnt(0)
ds_write_b32 v6, v8
v_mov_b64 v[192:193], v[208:209]
v_mov_b64 v[194:195], v[210:211]
v_mov_b64 v[196:197], v[212:213]
v_mov_b64 v[198:199], v[214:215]
v_mov_b64 v[200:201], v[216:217]
v_mov_b64 v[202:203], v[218:219]
v_mov_b64 v[204:205], v[220:221]
v_mov_b64 v[206:207], v[222:223]
KP_x1_j:
s_mov_b32 s97, 0
KP_x1_sp:
ds_read_b32 v10, v7
s_add_u32 s97, s97, 1
s_waitcnt lgkmcnt(0)
v_cmp_gt_u32 vcc, 1, v10
s_cmp_ge_u32 s97, 2097152
s_cbranch_scc1 KP_x1_sp_done
s_cbranch_vccnz KP_x1_sp
KP_x1_sp_done:
ds_read_b128 v[16:19], v5 offset:0
ds_read_b128 v[20:23], v5 offset:1024
ds_read_b128 v[24:27], v5 offset:2048
ds_read_b128 v[28:31], v5 offset:3072
s_waitcnt lgkmcnt(3)
v_add_f32 v16, v16, v192
v_add_f32 v17, v17, v193
v_add_f32 v18, v18, v194
v_add_f32 v19, v19, v195
v_cvt_pk_bf16_f32 v32, v16, v17
v_cvt_pk_bf16_f32 v33, v18, v19
s_waitcnt lgkmcnt(2)
v_add_f32 v20, v20, v196
v_add_f32 v21, v21, v197
v_add_f32 v22, v22, v198
v_add_f32 v23, v23, v199
v_cvt_pk_bf16_f32 v34, v20, v21
v_cvt_pk_bf16_f32 v35, v22, v23
s_waitcnt lgkmcnt(1)
v_add_f32 v24, v24, v200
v_add_f32 v25, v25, v201
v_add_f32 v26, v26, v202
v_add_f32 v27, v27, v203
v_cvt_pk_bf16_f32 v36, v24, v25
v_cvt_pk_bf16_f32 v37, v26, v27
s_waitcnt lgkmcnt(0)
v_add_f32 v28, v28, v204
v_add_f32 v29, v29, v205
v_add_f32 v30, v30, v206
v_add_f32 v31, v31, v207
v_cvt_pk_bf16_f32 v38, v28, v29
v_cvt_pk_bf16_f32 v39, v30, v31
ds_write_b64 v9, v[32:33] offset:0
ds_write_b64 v9, v[34:35] offset:512
ds_write_b64 v9, v[36:37] offset:1024
ds_write_b64 v9, v[38:39] offset:1536
s_waitcnt lgkmcnt(0)
ds_read_b128 v[40:43], v5 offset:0
ds_read_b128 v[44:47], v5 offset:1024
s_mul_i32 s85, s83, 3277
s_lshr_b32 s85, s85, 16
s_mul_i32 s87, s85, 20
s_sub_u32 s87, s83, s87
s_lshl_b32 s88, s82, 5
s_add_u32 s85, s85, s88
s_mul_i32 s85, s85, 4352
s_lshl2_add_u32 s85, s87, s85
s_add_u32 s85, s85, 15015936
s_waitcnt lgkmcnt(1)
buffer_store_dwordx4 v[40:43], v1, s[12:15], s84 offen offset:0 sc1
s_waitcnt lgkmcnt(0)
buffer_store_dwordx4 v[44:47], v1, s[12:15], s84 offen offset:1024 sc1
v_mov_b32 v8, 2
ds_write_b32 v6, v8
v_mov_b32 v10, 0
v_mov_b32 v11, s96
s_add_u32 s83, s83, 2
s_lshl_b32 s76, s3, 12
s_add_u32 s76, s76, 146304
s_xor_b32 s77, s3, 1
s_lshl_b32 s77, s77, 12
s_add_u32 s77, s77, 146304
s_waitcnt lgkmcnt(0)
v_mfma_f32_16x16x32_bf16 v[220:223], v[140:143], v[176:179], 0
ds_read2_b64 v[64:67], v12 offset0:8 offset1:9
v_mfma_f32_16x16x32_bf16 v[216:219], v[140:143], v[172:175], 0
ds_read_b128 v[96:99], v14 offset:3648
v_mfma_f32_16x16x32_bf16 v[212:215], v[136:139], v[172:175], 0
v_mfma_f32_16x16x32_bf16 v[208:211], v[136:139], v[168:171], 0
ds_read2_b64 v[68:71], v12 offset0:72 offset1:73
v_mfma_f32_16x16x32_bf16 v[220:223], v[144:147], v[172:175], v[220:223]
ds_read_b128 v[100:103], v14 offset:3136
v_mfma_f32_16x16x32_bf16 v[216:219], v[136:139], v[176:179], v[216:219]
v_mfma_f32_16x16x32_bf16 v[212:215], v[140:143], v[168:171], v[212:215]
ds_read2_b64 v[72:75], v12 offset0:136 offset1:137
v_mfma_f32_16x16x32_bf16 v[204:207], v[132:135], v[168:171], 0
ds_read_b128 v[104:107], v14 offset:2624
v_mfma_f32_16x16x32_bf16 v[220:223], v[136:139], v[180:183], v[220:223]
v_mfma_f32_16x16x32_bf16 v[216:219], v[144:147], v[168:171], v[216:219]
ds_read2_b64 v[76:79], v12 offset0:200 offset1:201
v_mfma_f32_16x16x32_bf16 v[208:211], v[132:135], v[172:175], v[208:211]
ds_read_b128 v[108:111], v14 offset:2112
v_mfma_f32_16x16x32_bf16 v[212:215], v[132:135], v[176:179], v[212:215]
v_mfma_f32_16x16x32_bf16 v[220:223], v[148:151], v[168:171], v[220:223]
ds_read2_b64 v[80:83], v13 offset0:8 offset1:9
v_mfma_f32_16x16x32_bf16 v[216:219], v[132:135], v[180:183], v[216:219]
ds_read_b128 v[112:115], v14 offset:1600
v_mfma_f32_16x16x32_bf16 v[200:203], v[132:135], v[164:167], 0
v_mfma_f32_16x16x32_bf16 v[204:207], v[136:139], v[164:167], v[204:207]
ds_read2_b64 v[84:87], v13 offset0:72 offset1:73
v_mfma_f32_16x16x32_bf16 v[220:223], v[132:135], v[184:187], v[220:223]
ds_read_b128 v[116:119], v14 offset:1088
v_mfma_f32_16x16x32_bf16 v[208:211], v[140:143], v[164:167], v[208:211]
v_mfma_f32_16x16x32_bf16 v[212:215], v[144:147], v[164:167], v[212:215]
ds_read2_b64 v[88:91], v13 offset0:136 offset1:137
v_mfma_f32_16x16x32_bf16 v[216:219], v[148:151], v[164:167], v[216:219]
ds_read_b128 v[120:123], v14 offset:576
v_mfma_f32_16x16x32_bf16 v[220:223], v[152:155], v[164:167], v[220:223]
v_mfma_f32_16x16x32_bf16 v[196:199], v[128:131], v[164:167], 0
ds_read2_b64 v[92:95], v13 offset0:200 offset1:201
v_mfma_f32_16x16x32_bf16 v[200:203], v[128:131], v[168:171], v[200:203]
ds_read_b128 v[124:127], v14 offset:64
v_mfma_f32_16x16x32_bf16 v[204:207], v[128:131], v[172:175], v[204:207]
v_mfma_f32_16x16x32_bf16 v[208:211], v[128:131], v[176:179], v[208:211]
v_mfma_f32_16x16x32_bf16 v[212:215], v[128:131], v[180:183], v[212:215]
v_mfma_f32_16x16x32_bf16 v[216:219], v[128:131], v[184:187], v[216:219]
v_mfma_f32_16x16x32_bf16 v[220:223], v[128:131], v[188:191], v[220:223]
v_mfma_f32_16x16x32_bf16 v[192:195], v[128:131], v[160:163], 0
v_mfma_f32_16x16x32_bf16 v[196:199], v[132:135], v[160:163], v[196:199]
v_mfma_f32_16x16x32_bf16 v[200:203], v[136:139], v[160:163], v[200:203]
v_mfma_f32_16x16x32_bf16 v[204:207], v[140:143], v[160:163], v[204:207]
v_mfma_f32_16x16x32_bf16 v[208:211], v[144:147], v[160:163], v[208:211]
v_mfma_f32_16x16x32_bf16 v[212:215], v[148:151], v[160:163], v[212:215]
v_mfma_f32_16x16x32_bf16 v[216:219], v[152:155], v[160:163], v[216:219]
v_mfma_f32_16x16x32_bf16 v[220:223], v[156:159], v[160:163], v[220:223]
s_waitcnt lgkmcnt(0)
v_mfma_f32_16x16x32_bf16 v[220:223], v[76:79], v[112:115], v[220:223]
ds_read2_b64 v[128:131], v12 offset0:16 offset1:17
v_mfma_f32_16x16x32_bf16 v[216:219], v[76:79], v[108:111], v[216:219]
ds_read_b128 v[160:163], v14 offset:3712
v_mfma_f32_16x16x32_bf16 v[212:215], v[72:75], v[108:111], v[212:215]
v_mfma_f32_16x16x32_bf16 v[208:211], v[72:75], v[104:107], v[208:211]
ds_read2_b64 v[132:135], v12 offset0:80 offset1:81
v_mfma_f32_16x16x32_bf16 v[220:223], v[80:83], v[108:111], v[220:223]
ds_read_b128 v[164:167], v14 offset:3200
v_mfma_f32_16x16x32_bf16 v[216:219], v[72:75], v[112:115], v[216:219]
v_mfma_f32_16x16x32_bf16 v[212:215], v[76:79], v[104:107], v[212:215]
ds_read2_b64 v[136:139], v12 offset0:144 offset1:145
v_mfma_f32_16x16x32_bf16 v[204:207], v[68:71], v[104:107], v[204:207]
ds_read_b128 v[168:171], v14 offset:2688
v_mfma_f32_16x16x32_bf16 v[220:223], v[72:75], v[116:119], v[220:223]
v_mfma_f32_16x16x32_bf16 v[216:219], v[80:83], v[104:107], v[216:219]
ds_read2_b64 v[140:143], v12 offset0:208 offset1:209
v_mfma_f32_16x16x32_bf16 v[208:211], v[68:71], v[108:111], v[208:211]
ds_read_b128 v[172:175], v14 offset:2176
v_mfma_f32_16x16x32_bf16 v[212:215], v[68:71], v[112:115], v[212:215]
v_mfma_f32_16x16x32_bf16 v[220:223], v[84:87], v[104:107], v[220:223]
ds_read2_b64 v[144:147], v13 offset0:16 offset1:17
v_mfma_f32_16x16x32_bf16 v[216:219], v[68:71], v[116:119], v[216:219]
ds_read_b128 v[176:179], v14 offset:1664
v_mfma_f32_16x16x32_bf16 v[200:203], v[68:71], v[100:103], v[200:203]
v_mfma_f32_16x16x32_bf16 v[204:207], v[72:75], v[100:103], v[204:207]
ds_read2_b64 v[148:151], v13 offset0:80 offset1:81
v_mfma_f32_16x16x32_bf16 v[220:223], v[68:71], v[120:123], v[220:223]
ds_read_b128 v[180:183], v14 offset:1152
v_mfma_f32_16x16x32_bf16 v[208:211], v[76:79], v[100:103], v[208:211]
v_mfma_f32_16x16x32_bf16 v[212:215], v[80:83], v[100:103], v[212:215]
ds_read2_b64 v[152:155], v13 offset0:144 offset1:145
v_mfma_f32_16x16x32_bf16 v[216:219], v[84:87], v[100:103], v[216:219]
ds_read_b128 v[184:187], v14 offset:640
v_mfma_f32_16x16x32_bf16 v[220:223], v[88:91], v[100:103], v[220:223]
v_mfma_f32_16x16x32_bf16 v[196:199], v[64:67], v[100:103], v[196:199]
ds_read2_b64 v[156:159], v13 offset0:208 offset1:209
v_mfma_f32_16x16x32_bf16 v[200:203], v[64:67], v[104:107], v[200:203]
ds_read_b128 v[188:191], v14 offset:128
v_mfma_f32_16x16x32_bf16 v[204:207], v[64:67], v[108:111], v[204:207]
v_mfma_f32_16x16x32_bf16 v[208:211], v[64:67], v[112:115], v[208:211]
v_mfma_f32_16x16x32_bf16 v[212:215], v[64:67], v[116:119], v[212:215]
v_mfma_f32_16x16x32_bf16 v[216:219], v[64:67], v[120:123], v[216:219]
v_mfma_f32_16x16x32_bf16 v[220:223], v[64:67], v[124:127], v[220:223]
v_mfma_f32_16x16x32_bf16 v[192:195], v[64:67], v[96:99], v[192:195]
v_mfma_f32_16x16x32_bf16 v[196:199], v[68:71], v[96:99], v[196:199]
v_mfma_f32_16x16x32_bf16 v[200:203], v[72:75], v[96:99], v[200:203]
v_mfma_f32_16x16x32_bf16 v[204:207], v[76:79], v[96:99], v[204:207]
v_mfma_f32_16x16x32_bf16 v[208:211], v[80:83], v[96:99], v[208:211]
v_mfma_f32_16x16x32_bf16 v[212:215], v[84:87], v[96:99], v[212:215]
v_mfma_f32_16x16x32_bf16 v[216:219], v[88:91], v[96:99], v[216:219]
v_mfma_f32_16x16x32_bf16 v[220:223], v[92:95], v[96:99], v[220:223]
s_waitcnt lgkmcnt(0)
v_mfma_f32_16x16x32_bf16 v[220:223], v[140:143], v[176:179], v[220:223]
ds_read2_b64 v[64:67], v12 offset0:24 offset1:25
v_mfma_f32_16x16x32_bf16 v[216:219], v[140:143], v[172:175], v[216:219]
ds_read_b128 v[96:99], v14 offset:3776
v_mfma_f32_16x16x32_bf16 v[212:215], v[136:139], v[172:175], v[212:215]
s_waitcnt vmcnt(0)
buffer_store_dword v11, v10, s[12:15], s85 offen sc1
v_mfma_f32_16x16x32_bf16 v[208:211], v[136:139], v[168:171], v[208:211]
ds_read2_b64 v[68:71], v12 offset0:88 offset1:89
v_mfma_f32_16x16x32_bf16 v[220:223], v[144:147], v[172:175], v[220:223]
ds_read_b128 v[100:103], v14 offset:3264
v_mfma_f32_16x16x32_bf16 v[216:219], v[136:139], v[176:179], v[216:219]
v_mfma_f32_16x16x32_bf16 v[212:215], v[140:143], v[168:171], v[212:215]
ds_read2_b64 v[72:75], v12 offset0:152 offset1:153
v_mfma_f32_16x16x32_bf16 v[204:207], v[132:135], v[168:171], v[204:207]
ds_read_b128 v[104:107], v14 offset:2752
v_mfma_f32_16x16x32_bf16 v[220:223], v[136:139], v[180:183], v[220:223]
v_mfma_f32_16x16x32_bf16 v[216:219], v[144:147], v[168:171], v[216:219]
ds_read2_b64 v[76:79], v12 offset0:216 offset1:217
v_mfma_f32_16x16x32_bf16 v[208:211], v[132:135], v[172:175], v[208:211]
ds_read_b128 v[108:111], v14 offset:2240
v_mfma_f32_16x16x32_bf16 v[212:215], v[132:135], v[176:179], v[212:215]
v_mfma_f32_16x16x32_bf16 v[220:223], v[148:151], v[168:171], v[220:223]
ds_read2_b64 v[80:83], v13 offset0:24 offset1:25
v_mfma_f32_16x16x32_bf16 v[216:219], v[132:135], v[180:183], v[216:219]
ds_read_b128 v[112:115], v14 offset:1728
v_mfma_f32_16x16x32_bf16 v[200:203], v[132:135], v[164:167], v[200:203]
v_mfma_f32_16x16x32_bf16 v[204:207], v[136:139], v[164:167], v[204:207]
ds_read2_b64 v[84:87], v13 offset0:88 offset1:89
v_mfma_f32_16x16x32_bf16 v[220:223], v[132:135], v[184:187], v[220:223]
ds_read_b128 v[116:119], v14 offset:1216
v_mfma_f32_16x16x32_bf16 v[208:211], v[140:143], v[164:167], v[208:211]
v_mfma_f32_16x16x32_bf16 v[212:215], v[144:147], v[164:167], v[212:215]
ds_read2_b64 v[88:91], v13 offset0:152 offset1:153
v_mfma_f32_16x16x32_bf16 v[216:219], v[148:151], v[164:167], v[216:219]
ds_read_b128 v[120:123], v14 offset:704
v_mfma_f32_16x16x32_bf16 v[220:223], v[152:155], v[164:167], v[220:223]
v_mfma_f32_16x16x32_bf16 v[196:199], v[128:131], v[164:167], v[196:199]
ds_read2_b64 v[92:95], v13 offset0:216 offset1:217
v_mfma_f32_16x16x32_bf16 v[200:203], v[128:131], v[168:171], v[200:203]
ds_read_b128 v[124:127], v14 offset:192
v_mfma_f32_16x16x32_bf16 v[204:207], v[128:131], v[172:175], v[204:207]
v_mfma_f32_16x16x32_bf16 v[208:211], v[128:131], v[176:179], v[208:211]
v_mfma_f32_16x16x32_bf16 v[212:215], v[128:131], v[180:183], v[212:215]
v_mfma_f32_16x16x32_bf16 v[216:219], v[128:131], v[184:187], v[216:219]
v_mfma_f32_16x16x32_bf16 v[220:223], v[128:131], v[188:191], v[220:223]
v_mfma_f32_16x16x32_bf16 v[192:195], v[128:131], v[160:163], v[192:195]
v_mfma_f32_16x16x32_bf16 v[196:199], v[132:135], v[160:163], v[196:199]
v_mfma_f32_16x16x32_bf16 v[200:203], v[136:139], v[160:163], v[200:203]
v_mfma_f32_16x16x32_bf16 v[204:207], v[140:143], v[160:163], v[204:207]
v_mfma_f32_16x16x32_bf16 v[208:211], v[144:147], v[160:163], v[208:211]
v_mfma_f32_16x16x32_bf16 v[212:215], v[148:151], v[160:163], v[212:215]
v_mfma_f32_16x16x32_bf16 v[216:219], v[152:155], v[160:163], v[216:219]
v_mfma_f32_16x16x32_bf16 v[220:223], v[156:159], v[160:163], v[220:223]
s_waitcnt lgkmcnt(0)
v_mfma_f32_16x16x32_bf16 v[220:223], v[76:79], v[112:115], v[220:223]
v_mfma_f32_16x16x32_bf16 v[216:219], v[76:79], v[108:111], v[216:219]
v_mfma_f32_16x16x32_bf16 v[212:215], v[72:75], v[108:111], v[212:215]
v_mfma_f32_16x16x32_bf16 v[208:211], v[72:75], v[104:107], v[208:211]
v_mfma_f32_16x16x32_bf16 v[220:223], v[80:83], v[108:111], v[220:223]
v_mfma_f32_16x16x32_bf16 v[216:219], v[72:75], v[112:115], v[216:219]
v_mfma_f32_16x16x32_bf16 v[212:215], v[76:79], v[104:107], v[212:215]
v_mfma_f32_16x16x32_bf16 v[204:207], v[68:71], v[104:107], v[204:207]
v_mfma_f32_16x16x32_bf16 v[220:223], v[72:75], v[116:119], v[220:223]
v_mfma_f32_16x16x32_bf16 v[216:219], v[80:83], v[104:107], v[216:219]
v_mfma_f32_16x16x32_bf16 v[208:211], v[68:71], v[108:111], v[208:211]
v_mfma_f32_16x16x32_bf16 v[212:215], v[68:71], v[112:115], v[212:215]
v_mfma_f32_16x16x32_bf16 v[220:223], v[84:87], v[104:107], v[220:223]
v_mfma_f32_16x16x32_bf16 v[216:219], v[68:71], v[116:119], v[216:219]
v_mfma_f32_16x16x32_bf16 v[200:203], v[68:71], v[100:103], v[200:203]
v_mfma_f32_16x16x32_bf16 v[204:207], v[72:75], v[100:103], v[204:207]
v_mfma_f32_16x16x32_bf16 v[220:223], v[68:71], v[120:123], v[220:223]
v_mfma_f32_16x16x32_bf16 v[208:211], v[76:79], v[100:103], v[208:211]
v_mfma_f32_16x16x32_bf16 v[212:215], v[80:83], v[100:103], v[212:215]
v_mfma_f32_16x16x32_bf16 v[216:219], v[84:87], v[100:103], v[216:219]
v_mfma_f32_16x16x32_bf16 v[220:223], v[88:91], v[100:103], v[220:223]
v_mfma_f32_16x16x32_bf16 v[196:199], v[64:67], v[100:103], v[196:199]
v_mfma_f32_16x16x32_bf16 v[200:203], v[64:67], v[104:107], v[200:203]
v_mfma_f32_16x16x32_bf16 v[204:207], v[64:67], v[108:111], v[204:207]
v_mfma_f32_16x16x32_bf16 v[208:211], v[64:67], v[112:115], v[208:211]
v_mfma_f32_16x16x32_bf16 v[212:215], v[64:67], v[116:119], v[212:215]
v_mfma_f32_16x16x32_bf16 v[216:219], v[64:67], v[120:123], v[216:219]
v_mfma_f32_16x16x32_bf16 v[220:223], v[64:67], v[124:127], v[220:223]
v_mfma_f32_16x16x32_bf16 v[192:195], v[64:67], v[96:99], v[192:195]
v_mfma_f32_16x16x32_bf16 v[196:199], v[68:71], v[96:99], v[196:199]
v_mfma_f32_16x16x32_bf16 v[200:203], v[72:75], v[96:99], v[200:203]
v_mfma_f32_16x16x32_bf16 v[204:207], v[76:79], v[96:99], v[204:207]
v_mfma_f32_16x16x32_bf16 v[208:211], v[80:83], v[96:99], v[208:211]
v_mfma_f32_16x16x32_bf16 v[212:215], v[84:87], v[96:99], v[212:215]
v_mfma_f32_16x16x32_bf16 v[216:219], v[88:91], v[96:99], v[216:219]
v_mfma_f32_16x16x32_bf16 v[220:223], v[92:95], v[96:99], v[220:223]
v_add_u32 v4, s77, v1
v_add_u32 v5, s76, v1
s_lshl_b32 s84, s3, 2
s_add_u32 s84, s84, 163712
v_mov_b32 v6, s84
v_xor_b32 v7, 4, v6
v_mov_b32 v8, 3
v_and_b32 v9, 15, v0
v_lshlrev_b32 v9, 5, v9
v_lshrrev_b32 v10, 4, v0
v_lshl_add_u32 v9, v10, 3, v9
v_add_u32 v9, s76, v9
s_lshl_b32 s84, s83, 12
s_lshl_b32 s85, s82, 11
s_add_u32 s84, s84, s85
s_add_u32 s84, s84, 2625536
s_cmp_eq_u32 s82, 0
s_cbranch_scc0 KP_x2_h1
ds_write_b128 v4, v[208:211] offset:0
ds_write_b128 v4, v[212:215] offset:1024
ds_write_b128 v4, v[216:219] offset:2048
ds_write_b128 v4, v[220:223] offset:3072
s_waitcnt lgkmcnt(0)
ds_write_b32 v6, v8
s_branch KP_x2_j
KP_x2_h1:
ds_write_b128 v4, v[192:195] offset:0
ds_write_b128 v4, v[196:199] offset:1024
ds_write_b128 v4, v[200:203] offset:2048
ds_write_b128 v4, v[204:207] offset:3072
s_waitcnt lgkmcnt(0)
ds_write_b32 v6, v8
v_mov_b64 v[192:193], v[208:209]
v_mov_b64 v[194:195], v[210:211]
v_mov_b64 v[196:197], v[212:213]
v_mov_b64 v[198:199], v[214:215]
v_mov_b64 v[200:201], v[216:217]
v_mov_b64 v[202:203], v[218:219]
v_mov_b64 v[204:205], v[220:221]
v_mov_b64 v[206:207], v[222:223]
KP_x2_j:
s_mov_b32 s97, 0
KP_x2_sp:
ds_read_b32 v10, v7
s_add_u32 s97, s97, 1
s_waitcnt lgkmcnt(0)
v_cmp_gt_u32 vcc, 3, v10
s_cmp_ge_u32 s97, 2097152
s_cbranch_scc1 KP_x2_sp_done
s_cbranch_vccnz KP_x2_sp
KP_x2_sp_done:
ds_read_b128 v[16:19], v5 offset:0
ds_read_b128 v[20:23], v5 offset:1024
ds_read_b128 v[24:27], v5 offset:2048
ds_read_b128 v[28:31], v5 offset:3072
s_waitcnt lgkmcnt(3)
v_add_f32 v16, v16, v192
v_add_f32 v17, v17, v193
v_add_f32 v18, v18, v194
v_add_f32 v19, v19, v195
v_cvt_pk_bf16_f32 v32, v16, v17
v_cvt_pk_bf16_f32 v33, v18, v19
s_waitcnt lgkmcnt(2)
v_add_f32 v20, v20, v196
v_add_f32 v21, v21, v197
v_add_f32 v22, v22, v198
v_add_f32 v23, v23, v199
v_cvt_pk_bf16_f32 v34, v20, v21
v_cvt_pk_bf16_f32 v35, v22, v23
s_waitcnt lgkmcnt(1)
v_add_f32 v24, v24, v200
v_add_f32 v25, v25, v201
v_add_f32 v26, v26, v202
v_add_f32 v27, v27, v203
v_cvt_pk_bf16_f32 v36, v24, v25
v_cvt_pk_bf16_f32 v37, v26, v27
s_waitcnt lgkmcnt(0)
v_add_f32 v28, v28, v204
v_add_f32 v29, v29, v205
v_add_f32 v30, v30, v206
v_add_f32 v31, v31, v207
v_cvt_pk_bf16_f32 v38, v28, v29
v_cvt_pk_bf16_f32 v39, v30, v31
ds_write_b64 v9, v[32:33] offset:0
ds_write_b64 v9, v[34:35] offset:512
ds_write_b64 v9, v[36:37] offset:1024
ds_write_b64 v9, v[38:39] offset:1536
s_waitcnt lgkmcnt(0)
ds_read_b128 v[40:43], v5 offset:0
ds_read_b128 v[44:47], v5 offset:1024
s_mul_i32 s85, s83, 3277
s_lshr_b32 s85, s85, 16
s_mul_i32 s87, s85, 20
s_sub_u32 s87, s83, s87
s_lshl_b32 s88, s82, 5
s_add_u32 s85, s85, s88
s_mul_i32 s85, s85, 4352
s_lshl2_add_u32 s85, s87, s85
s_add_u32 s85, s85, 15015936
s_waitcnt lgkmcnt(1)
buffer_store_dwordx4 v[40:43], v1, s[12:15], s84 offen offset:0 sc1
s_waitcnt lgkmcnt(0)
buffer_store_dwordx4 v[44:47], v1, s[12:15], s84 offen offset:1024 sc1
v_mov_b32 v10, 0
v_mov_b32 v11, s96
s_waitcnt vmcnt(0)
buffer_store_dword v11, v10, s[12:15], s85 offen sc1
s_lshr_b32 s88, s70, 4
s_lshl_b32 s88, s88, 5
s_lshl2_add_u32 s87, s71, s3
s_add_u32 s88, s88, s87
s_mul_i32 s88, s88, 4352
s_add_u32 s86, s88, 15015936
v_min_u32 v4, 19, v0
v_lshlrev_b32 v4, 2, v4
v_bfe_u32 v5, v0, 4, 1
s_and_b32 s88, s3, 1
s_lshl_b32 s88, s88, 2
v_lshl_or_b32 v5, v5, 1, s88
v_xor_b32 v5, v5, v0
v_and_b32 v5, 7, v5
v_lshrrev_b32 v6, 3, v0
v_lshlrev_b32 v6, 12, v6
v_lshl_add_u32 v5, v5, 4, v6
s_mul_i32 s87, s87, 81920
s_lshl_b32 s88, s70, 7
s_add_u32 s87, s87, s88
s_add_u32 s87, s87, 2625536
s_add_u32 s84, s87, 31744
s_add_u32 s85, s87, 63488
s_lshl_b32 s88, s3, 12
s_add_u32 m0, s88, 146304
s_setprio 0
s_lshl_b32 s88, s3, 2
s_add_u32 s88, s88, 163744
v_mov_b32 v8, s88
s_mov_b32 s97, 0
KP_ys:
ds_read_b32 v9, v8
s_add_u32 s97, s97, 1
s_waitcnt lgkmcnt(0)
v_cmp_gt_u32 vcc, 1, v9
s_cmp_ge_u32 s97, 2097152
s_cbranch_scc1 KP_ys_done
s_cbranch_vccnz KP_ys
KP_ys_done:
s_mov_b32 s97, 0
KP_yp_loop:
buffer_load_dword v7, v4, s[12:15], s86 offen sc1
s_add_u32 s97, s97, 1
s_waitcnt vmcnt(0)
v_cmp_ne_u32 vcc, s96, v7
s_cmp_ge_u32 s97, 32768
s_cbranch_scc1 KP_yp_done
s_cbranch_vccnz KP_yp_loop
KP_yp_done:
buffer_load_dwordx4 v5, s[12:15], s87 offen lds
buffer_load_dwordx4 v5, s[12:15], s84 offen offset:1024 lds
s_mov_b32 exec_hi, 0
buffer_load_dwordx4 v5, s[12:15], s85 offen offset:2048 lds
s_mov_b64 exec, -1
s_waitcnt vmcnt(0)
s_barrier
s_endpgm
KP_G0:
s_lshl_b32 s84, s2, 6
s_add_u32 s84, s84, 13537292
v_mov_b32 v10, 0
s_mov_b64 exec, 1
buffer_store_dword v11, v10, s[12:15], s84 offen sc1
s_mov_b64 exec, -1
v_add_u32 v3, 4096, v1
s_mov_b32 s4, s32
s_mov_b32 s5, s33
s_mov_b32 s6, 2621440
s_mov_b32 s7, 0x20000
s_mov_b32 s16, s54
s_mov_b32 s17, s55
s_movk_i32 s18, 1280
s_mov_b32 s19, 0x20000
s_mov_b32 s24, s58
s_mov_b32 s25, s59
s_mov_b32 s26, 2621440
s_mov_b32 s27, 0x20000
v_lshrrev_b32 v12, 4, v0
v_mul_u32_u24 v12, 40, v12
v_and_b32 v13, 15, v0
v_mul_u32_u24 v15, 1280, v13
v_add_u32 v15, v15, v12
v_lshlrev_b32 v13, 4, v13
v_min_u32 v14, 23, v0
v_lshlrev_b32 v14, 2, v14
s_mul_i32 s61, s71, 160
s_lshl2_add_u32 s101, s70, s3
s_mul_i32 s100, s101, 20480
s_add_u32 s100, s100, s61
s_lshl_b32 s101, s101, 8
s_add_u32 s101, s101, 13504512
s_mul_i32 s98, s70, 196608
s_mul_i32 s85, s3, 49152
s_add_u32 s98, s98, s85
s_add_u32 s98, s98, 7213056
s_mul_i32 s99, s71, 245760
s_mul_i32 s85, s3, 12
s_add_u32 s85, s85, s92
s_mul_i32 s85, s85, 5120
s_add_u32 s99, s99, s85
s_add_u32 s99, s99, 5246976
s_sub_u32 s60, s99, 61440
s_lshr_b32 s93, s64, 1
s_lshl3_add_u32 s93, s93, s71
s_lshl2_add_u32 s93, s93, s3
s_mul_i32 s93, s93, 4352
s_add_u32 s93, s93, 14458880
buffer_load_dwordx4 v[184:187], v12, s[16:19], s61 offen
buffer_load_dwordx4 v[188:191], v12, s[16:19], s61 offen offset:16
buffer_load_dwordx2 v[192:193], v12, s[16:19], s61 offen offset:32
buffer_load_dwordx4 v[244:247], v15, s[4:7], s100 offen
buffer_load_dwordx4 v[248:251], v15, s[4:7], s100 offen offset:16
buffer_load_dwordx2 v[252:253], v15, s[4:7], s100 offen offset:32
s_mul_i32 s72, s3, 5120
s_mul_i32 s73, s82, 10240
s_add_u32 s73, s73, s86
s_mov_b32 s97, 0
KP_wp_loop:
buffer_load_dword v130, v14, s[12:15], s93 offen sc1
s_add_u32 s97, s97, 1
s_waitcnt vmcnt(0)
v_cmp_ne_u32 vcc, s96, v130
s_cmp_ge_u32 s97, 32768
s_cbranch_scc1 KP_wp_done
s_cbranch_vccnz KP_wp_loop
KP_wp_done:
s_cmp_ge_u32 s92, 12
s_cselect_b32 s81, s60, s99
s_add_u32 s81, s81, 0
buffer_load_dwordx4 v[16:19], v1, s[12:15], s81 offen offset:0
buffer_load_dwordx4 v[20:23], v1, s[12:15], s81 offen offset:1024
buffer_load_dwordx4 v[24:27], v1, s[12:15], s81 offen offset:2048
buffer_load_dwordx4 v[28:31], v1, s[12:15], s81 offen offset:3072
buffer_load_dwordx4 v[32:35], v3, s[12:15], s81 offen offset:0
s_cmp_ge_u32 s92, 11
s_cselect_b32 s81, s60, s99
s_add_u32 s81, s81, 5120
buffer_load_dwordx4 v[36:39], v1, s[12:15], s81 offen offset:0
buffer_load_dwordx4 v[40:43], v1, s[12:15], s81 offen offset:1024
buffer_load_dwordx4 v[44:47], v1, s[12:15], s81 offen offset:2048
buffer_load_dwordx4 v[48:51], v1, s[12:15], s81 offen offset:3072
buffer_load_dwordx4 v[52:55], v3, s[12:15], s81 offen offset:0
s_cmp_ge_u32 s92, 10
s_cselect_b32 s81, s60, s99
s_add_u32 s81, s81, 10240
buffer_load_dwordx4 v[56:59], v1, s[12:15], s81 offen offset:0
buffer_load_dwordx4 v[60:63], v1, s[12:15], s81 offen offset:1024
buffer_load_dwordx4 v[64:67], v1, s[12:15], s81 offen offset:2048
buffer_load_dwordx4 v[68:71], v1, s[12:15], s81 offen offset:3072
buffer_load_dwordx4 v[72:75], v3, s[12:15], s81 offen offset:0
s_cmp_ge_u32 s92, 9
s_cselect_b32 s81, s60, s99
s_add_u32 s81, s81, 15360
buffer_load_dwordx4 v[76:79], v1, s[12:15], s81 offen offset:0
buffer_load_dwordx4 v[80:83], v1, s[12:15], s81 offen offset:1024
buffer_load_dwordx4 v[84:87], v1, s[12:15], s81 offen offset:2048
buffer_load_dwordx4 v[88:91], v1, s[12:15], s81 offen offset:3072
buffer_load_dwordx4 v[92:95], v3, s[12:15], s81 offen offset:0
s_cmp_ge_u32 s92, 8
s_cselect_b32 s81, s60, s99
s_add_u32 s81, s81, 20480
buffer_load_dwordx4 v[96:99], v1, s[12:15], s81 offen offset:0
buffer_load_dwordx4 v[100:103], v1, s[12:15], s81 offen offset:1024
buffer_load_dwordx4 v[104:107], v1, s[12:15], s81 offen offset:2048
buffer_load_dwordx4 v[108:111], v1, s[12:15], s81 offen offset:3072
buffer_load_dwordx4 v[112:115], v3, s[12:15], s81 offen offset:0
s_add_u32 m0, s72, 0
s_cmp_ge_u32 s92, 7
s_cselect_b32 s76, s60, s99
s_add_u32 s76, s76, 25600
buffer_load_dwordx4 v1, s[12:15], s76 offen offset:0 lds
buffer_load_dwordx4 v1, s[12:15], s76 offen offset:1024 lds
buffer_load_dwordx4 v1, s[12:15], s76 offen offset:2048 lds
buffer_load_dwordx4 v1, s[12:15], s76 offen offset:3072 lds
s_add_u32 m0, s72, 4096
s_add_u32 s76, s76, 4096
buffer_load_dwordx4 v1, s[12:15], s76 offen offset:0 lds
s_add_u32 m0, s72, 20480
s_cmp_ge_u32 s92, 6
s_cselect_b32 s76, s60, s99
s_add_u32 s76, s76, 30720
buffer_load_dwordx4 v1, s[12:15], s76 offen offset:0 lds
buffer_load_dwordx4 v1, s[12:15], s76 offen offset:1024 lds
buffer_load_dwordx4 v1, s[12:15], s76 offen offset:2048 lds
buffer_load_dwordx4 v1, s[12:15], s76 offen offset:3072 lds
s_add_u32 m0, s72, 24576
s_add_u32 s76, s76, 4096
buffer_load_dwordx4 v1, s[12:15], s76 offen offset:0 lds
s_or_b32 s84, s2, s3
s_cbranch_scc1 KP_noe
v_lshlrev_b32 v4, 8, v0
s_mov_b32 s84, 13537292
s_mov_b32 s97, 0
KP_ep_loop:
buffer_load_dword v5, v4, s[12:15], s84 offen offset:0 sc1
buffer_load_dword v6, v4, s[12:15], s84 offen offset:64 sc1
buffer_load_dword v7, v4, s[12:15], s84 offen offset:128 sc1
buffer_load_dword v8, v4, s[12:15], s84 offen offset:192 sc1
s_add_u32 s97, s97, 1
s_waitcnt vmcnt(0)
v_cmp_ne_u32 vcc, s96, v5
v_cmp_ne_u32 s[88:89], s96, v6
s_or_b64 vcc, vcc, s[88:89]
v_cmp_ne_u32 s[88:89], s96, v7
s_or_b64 vcc, vcc, s[88:89]
v_cmp_ne_u32 s[88:89], s96, v8
s_or_b64 vcc, vcc, s[88:89]
s_cmp_ge_u32 s97, 32768
s_cbranch_scc1 KP_ep_done
s_cbranch_vccnz KP_ep_loop
KP_ep_done:
s_mov_b64 exec, 1
buffer_store_dword v11, v10, s[12:15], 0 offen offset:0 sc1
s_mov_b64 exec, -1
KP_noe:
s_lshl_b32 s84, s3, 2
s_add_u32 s84, s84, 163728
v_mov_b32 v2, s84
s_xor_b32 s84, s3, 0
s_lshl_b32 s84, s84, 10
v_add_u32 v4, s84, v1
s_xor_b32 s84, s3, 1
s_lshl_b32 s84, s84, 10
v_add_u32 v5, s84, v1
s_xor_b32 s84, s3, 2
s_lshl_b32 s84, s84, 10
v_add_u32 v6, s84, v1
s_xor_b32 s84, s3, 3
s_lshl_b32 s84, s84, 10
v_add_u32 v7, s84, v1
s_mul_i32 s84, s3, 5120
v_add_u32 v8, s84, v1
s_lshr_b32 s84, s3, 1
s_mul_i32 s84, s84, 21216
s_and_b32 s85, s3, 1
s_mul_i32 s85, s85, 10240
s_add_u32 s84, s84, s85
s_add_u32 s84, s84, 61440
v_add_u32 v9, s84, v1
ds_write_b32 v2, v2
s_lshl_b32 s84, s3, 2
s_add_u32 s84, s84, 163712
v_mov_b32 v10, s84
s_mov_b32 s97, 0
KP_ls:
ds_read_b32 v11, v10
s_add_u32 s97, s97, 1
s_waitcnt lgkmcnt(0)
v_cmp_gt_u32 vcc, 2, v11
s_cmp_ge_u32 s97, 2097152
s_cbranch_scc1 KP_ls_done
s_cbranch_vccnz KP_ls
KP_ls_done:
s_add_u32 m0, s72, 40960
s_cmp_ge_u32 s92, 5
s_cselect_b32 s76, s60, s99
s_add_u32 s76, s76, 35840
buffer_load_dwordx4 v1, s[12:15], s76 offen offset:0 lds
buffer_load_dwordx4 v1, s[12:15], s76 offen offset:1024 lds
buffer_load_dwordx4 v1, s[12:15], s76 offen offset:2048 lds
buffer_load_dwordx4 v1, s[12:15], s76 offen offset:3072 lds
s_add_u32 m0, s72, 45056
s_add_u32 s76, s76, 4096
buffer_load_dwordx4 v1, s[12:15], s76 offen offset:0 lds
s_add_u32 m0, s73, 0
s_cmp_ge_u32 s92, 4
s_cselect_b32 s76, s60, s99
s_add_u32 s76, s76, 40960
buffer_load_dwordx4 v1, s[12:15], s76 offen offset:0 lds
buffer_load_dwordx4 v1, s[12:15], s76 offen offset:1024 lds
buffer_load_dwordx4 v1, s[12:15], s76 offen offset:2048 lds
buffer_load_dwordx4 v1, s[12:15], s76 offen offset:3072 lds
s_add_u32 m0, s73, 4096
s_add_u32 s76, s76, 4096
buffer_load_dwordx4 v1, s[12:15], s76 offen offset:0 lds
s_add_u32 m0, s73, 5120
s_cmp_ge_u32 s92, 3
s_cselect_b32 s76, s60, s99
s_add_u32 s76, s76, 46080
buffer_load_dwordx4 v1, s[12:15], s76 offen offset:0 lds
buffer_load_dwordx4 v1, s[12:15], s76 offen offset:1024 lds
buffer_load_dwordx4 v1, s[12:15], s76 offen offset:2048 lds
buffer_load_dwordx4 v1, s[12:15], s76 offen offset:3072 lds
s_add_u32 m0, s73, 9216
s_add_u32 s76, s76, 4096
buffer_load_dwordx4 v1, s[12:15], s76 offen offset:0 lds
s_lshl2_add_u32 s84, s70, s3
s_mul_i32 s84, s84, 4352
s_add_u32 s84, s84, 13553664
v_min_u32 v10, 5, v0
v_lshlrev_b32 v10, 2, v10
s_mov_b32 s97, 0
KP_hp_loop:
buffer_load_dword v11, v10, s[12:15], s84 offen sc1
s_add_u32 s97, s97, 1
s_waitcnt vmcnt(0)
v_cmp_ne_u32 vcc, s96, v11
s_cmp_ge_u32 s97, 32768
s_cbranch_scc1 KP_hp_done
s_cbranch_vccnz KP_hp_loop
KP_hp_done:
s_branch G2
K_end:
s_endpgm
.section .rodata,"a"
.p2align 6
.amdhsa_kernel gated_mix__ssm_conv_h3__mixer_channel_mlp__prompt_kernel
  .amdhsa_next_free_vgpr 256
  .amdhsa_next_free_sgpr 102
  .amdhsa_accum_offset 256
  .amdhsa_group_segment_fixed_size 0
  .amdhsa_kernarg_size 120
  .amdhsa_user_sgpr_count 2
  .amdhsa_user_sgpr_kernarg_segment_ptr 1
  .amdhsa_system_sgpr_workgroup_id_x 1
.end_amdhsa_kernel
```
